```python
import torch

def _softmax(x, axis=-1):
    return torch.softmax(x, dim=axis)
def _gelu(x):
    return torch.nn.functional.gelu(x, approximate="tanh")
def _silu(x):
    return torch.nn.functional.silu(x)
def _sigmoid(x):
    return torch.sigmoid(x)
def _layernorm(x, axis=-1, eps=1e-5):
    m = x.mean(dim=axis, keepdim=True)
    v = x.var(dim=axis, keepdim=True, unbiased=False)
    return (x - m) / torch.sqrt(v + eps)
def _scatter_add(tgt, idx, src, axis=0):
    return tgt.clone().index_add_(axis, idx, src)
def _segment_sum(src, seg, n):
    out = torch.zeros((n,) + src.shape[1:], dtype=src.dtype)
    return out.index_add_(0, seg, src)
def _pad(x, pw):
    flat = tuple(v for pair in reversed(pw) for v in pair)
    return torch.nn.functional.pad(x, flat)

kernel_name = 'gated_mix__softmax_full_mha__dense_activation_mish__prompt'

def setup_inputs():

    _w = (lambda a: (lambda t: t.to(torch.bfloat16) if t.is_floating_point() else t)(torch.as_tensor(a)))
    def _A_setup():
        B, S, D = 1, 2048, 640
        return {
            "x": _w((lambda *s: torch.randn(*s, dtype=torch.bfloat16) * 0.05)(B, S, D)),
            "wqkv": _w((lambda *s: torch.randn(*s, dtype=torch.bfloat16) * 0.8)(D, 3 * D)),
            "wo": _w((lambda *s: torch.randn(*s, dtype=torch.bfloat16) * 0.05)(D, D)),
        }
    _A_in = _A_setup()

    def _B_setup():
        B, S, D, F = 1, 2048, 640, 1536
        return {
            "x": _w((lambda *s: torch.randn(*s, dtype=torch.bfloat16) * 0.05)(B, S, D)),
            "w1": _w((lambda *s: torch.randn(*s, dtype=torch.bfloat16) * 12.8)(D, F) * (D ** -0.5)),
            "b1": _w((lambda *s: torch.randn(*s, dtype=torch.bfloat16) * 0.2)(F)),
            "w2": _w((lambda *s: torch.randn(*s, dtype=torch.bfloat16) * 0.2)(F, D) * (F ** -0.5)),
        }
    _B_in = _B_setup()

    return {
        "A_x": _A_in["x"],
        "A_wqkv": _A_in["wqkv"],
        "A_wo": _A_in["wo"],
        "B_x": _B_in["x"],
        "B_w1": _B_in["w1"],
        "B_b1": _B_in["b1"],
        "B_w2": _B_in["w2"],
        "gate_w": _w((lambda *s: torch.randn(*s, dtype=torch.bfloat16) * 0.05)(640) * 16.0),
    }

def reference(A_x, A_wqkv, A_wo, B_x, B_w1, B_b1, B_w2, gate_w):
    def _A_ref(x, wqkv, wo):
        B, S, D = x.shape
        H = 32; Dh = D // H
        qkv = (lambda x, *d: x.permute(*d))((x @ wqkv).reshape(B, S, 3, H, Dh), 2, 0, 3, 1, 4)
        q, k, v = qkv[0], qkv[1], qkv[2]
        scale = Dh ** -0.5
        scores = torch.einsum("bhqd,bhkd->bhqk", q, k) * scale
        p = _softmax(scores, axis=-1)
        o = torch.einsum("bhqk,bhkd->bhqd", p, v)
        return (lambda x, *d: x.permute(*d))(o, 0, 2, 1, 3).reshape(B, S, D) @ wo

    def _B_ref(x, w1, b1, w2):
        h = torch.einsum("bsd,df->bsf", x, w1) + b1
        sp = torch.log1p(torch.exp(-torch.abs(h))) + torch.where(h > 0, h, torch.zeros_like(h))
        act = h * torch.tanh(sp)
        return torch.einsum("bsf,fd->bsd", act, w2)

    x = A_x
    g = _sigmoid((x * gate_w).sum(-1, keepdims=True))
    a = _A_ref(x, A_wqkv, A_wo)
    b = _B_ref(x, B_w1, B_b1, B_w2)
    return g * a + (1 - g) * b
```

```asm
; @launch grid=(256,1,1) block=(768,1,1) lds=155904
.amdgcn_target "amdgcn-amd-amdhsa--gfx950"
.text
.globl gated_mix__softmax_full_mha__dense_activation_mish__prompt_kernel
.p2align 8
.type gated_mix__softmax_full_mha__dense_activation_mish__prompt_kernel,@function
gated_mix__softmax_full_mha__dense_activation_mish__prompt_kernel:
    s_cmp_ge_u32 s2, 256
    s_cbranch_scc1 Lk1_exit
    s_load_dwordx2 s[80:81], s[0:1], 48
    s_load_dwordx2 s[82:83], s[0:1], 16
    s_load_dwordx4 s[4:7], s[0:1], 0
    s_load_dwordx4 s[8:11], s[0:1], 32
    s_load_dwordx2 s[12:13], s[0:1], 56
    s_load_dwordx2 s[14:15], s[0:1], 80
    v_lshrrev_b32 v1, 6, v0
    v_and_b32 v2, 63, v0
    s_and_b32 s41, s2, 7
    v_readfirstlane_b32 s32, v1
    s_nop 3
    s_mov_b32 s85, s32
    s_sub_u32 s42, s32, 4
    s_add_u32 s43, s32, 4
    s_cmp_ge_u32 s32, 8
    s_cselect_b32 s43, s42, s43
    s_cmp_lt_u32 s32, 4
    s_cselect_b32 s32, s32, s43
    s_lshr_b32 s42, s2, 3
    s_and_b32 s43, s41, 1
    s_lshl_b32 s43, s43, 3
    s_and_b32 s44, s42, 7
    s_add_u32 s34, s43, s44
    s_lshr_b32 s43, s41, 1
    s_lshl_b32 s43, s43, 2
    s_lshr_b32 s44, s42, 3
    s_add_u32 s35, s43, s44
    s_mul_i32 s45, s35, 52
    s_lshr_b32 s45, s45, 8
    s_add_u32 s33, s45, 1
    s_mul_i32 s45, s45, 5
    s_sub_u32 s46, s35, s45
    s_cmp_eq_u32 s35, 15
    s_cselect_b32 s33, 0, s33
    v_lshrrev_b32 v3, 3, v2
    v_mul_u32_u24 v3, 1280, v3
    v_and_b32 v13, 7, v2
    v_lshrrev_b32 v14, 4, v2
    v_xor_b32 v15, v13, v14
    v_lshl_add_u32 v10, v15, 4, v3
    v_xor_b32 v15, 4, v15
    v_lshl_add_u32 v11, v15, 4, v3
    s_lshl_b32 s37, s34, 7
    s_lshl_b32 s41, s32, 4
    s_lshl_b32 s42, s32, 11
    s_add_u32 s37, s37, s41
    s_mul_i32 s37, s37, 1280
    s_lshr_b32 s57, s2, 3
    s_and_b32 s78, s57, 7
    s_lshr_b32 s57, s57, 3
    s_lshl_b32 s57, s57, 1
    s_add_u32 s78, s78, s57
    s_mul_i32 s78, s78, 1
    s_mov_b32 s56, 0
    s_mov_b32 s69, 0
    s_mov_b32 s58, s37
    s_mov_b32 s79, 0
    s_waitcnt lgkmcnt(0)
    s_mov_b32 s16, s4
    s_and_b32 s17, s5, 0xffff
    s_mov_b32 s18, 2621440
    s_mov_b32 s19, 0x00020000
    s_mov_b32 s24, s14
    s_and_b32 s25, s15, 0xffff
    s_mov_b32 s26, 33554432
    s_mov_b32 s27, 0x00020000
    s_mov_b32 s60, s6
    s_and_b32 s61, s7, 0xffff
    s_mov_b32 s62, 2457600
    s_mov_b32 s63, 0x00020000
    s_mov_b32 s64, s8
    s_and_b32 s65, s9, 0xffff
    s_mov_b32 s66, 1966080
    s_mov_b32 s67, 0x00020000
    s_cmp_ge_u32 s32, 8
    s_cbranch_scc1 Lk1_H
    s_cmp_ge_u32 s32, 4
    s_cbranch_scc1 Lk1_R
    s_cmp_eq_u32 s33, 0
    s_cbranch_scc1 Lk1_gate
    s_mov_b32 s20, s6
    s_and_b32 s21, s7, 0xffff
    s_mov_b32 s22, 2457600
    s_mov_b32 s23, 0x00020000
    s_mov_b32 s36, 3840
    v_and_b32 v13, 15, v2
    v_lshlrev_b32 v15, 2, v14
    v_xor_b32 v13, v13, v15
    v_mul_u32_u24 v15, 3840, v14
    v_lshl_add_u32 v12, v13, 4, v15
    s_mul_i32 s38, s32, 61440
    s_lshl_b32 s41, s35, 8
    s_add_u32 s59, s38, s41
    s_mul_i32 s57, s79, 245760
    s_add_u32 s38, s59, s57
    s_lshl_b32 s43, s32, 12
    s_add_u32 s43, s43, 16384
    s_add_u32 s52, s42, 0
    s_add_u32 s53, s43, 0
    s_add_u32 m0, s52, 0
    s_add_u32 s48, s37, 0
    buffer_load_dwordx4 v10, s[16:19], s48 offen lds
    s_add_u32 m0, s52, 1024
    s_add_u32 s48, s37, 10240
    buffer_load_dwordx4 v11, s[16:19], s48 offen lds
    s_add_u32 m0, s53, 0
    s_add_u32 s48, s38, 0
    buffer_load_dwordx4 v12, s[20:23], s48 offen lds
    s_add_u32 m0, s53, 1024
    s_add_u32 s48, s38, 15360
    buffer_load_dwordx4 v12, s[20:23], s48 offen lds
    s_add_u32 m0, s53, 2048
    s_add_u32 s48, s38, 30720
    buffer_load_dwordx4 v12, s[20:23], s48 offen lds
    s_add_u32 m0, s53, 3072
    s_add_u32 s48, s38, 46080
    buffer_load_dwordx4 v12, s[20:23], s48 offen lds
    s_add_u32 s56, s56, 1
    s_add_u32 s57, s56, s78
    s_sub_u32 s57, s57, 2
    s_and_b32 s57, s57, 7
    s_add_u32 s57, s57, 2
    s_cmp_lt_u32 s56, 2
    s_cselect_b32 s79, s56, s57
    s_lshl_b32 s57, s79, 7
    s_add_u32 s37, s58, s57
    s_mul_i32 s57, s79, 245760
    s_add_u32 s38, s59, s57
    s_barrier
    s_lshr_b32 s41, s32, 1
    s_lshl_b32 s41, s41, 13
    v_and_b32 v3, 31, v2
    v_lshrrev_b32 v13, 5, v2
    v_bfe_u32 v14, v2, 1, 3
    v_xor_b32 v14, v13, v14
    v_lshlrev_b32 v14, 4, v14
    v_lshl_add_u32 v14, v3, 7, v14
    v_add_u32 v56, s41, v14
    v_xor_b32 v57, 32, v56
    v_xor_b32 v58, 64, v56
    v_xor_b32 v59, 96, v56
    v_bfe_u32 v14, v2, 2, 2
    v_lshl_add_u32 v15, v13, 3, v14
    v_lshlrev_b32 v15, 8, v15
    v_bfe_u32 v3, v2, 4, 1
    v_lshl_add_u32 v15, v3, 5, v15
    v_and_b32 v3, 3, v2
    v_lshl_add_u32 v15, v3, 3, v15
    v_add_u32 v15, 16384, v15
    s_and_b32 s41, s32, 1
    s_lshl_b32 s41, s41, 1
    v_xor_b32 v3, s41, v14
    v_lshl_add_u32 v60, v3, 6, v15
    v_xor_b32 v3, 1, v3
    v_lshl_add_u32 v61, v3, 6, v15
    s_add_u32 s52, s42, 45056
    s_add_u32 s53, s43, 45056
    s_add_u32 m0, s52, 0
    s_add_u32 s48, s37, 0
    buffer_load_dwordx4 v10, s[16:19], s48 offen lds
    s_add_u32 m0, s52, 1024
    s_add_u32 s48, s37, 10240
    buffer_load_dwordx4 v11, s[16:19], s48 offen lds
    s_add_u32 m0, s53, 0
    s_add_u32 s48, s38, 0
    buffer_load_dwordx4 v12, s[20:23], s48 offen lds
    s_add_u32 m0, s53, 1024
    s_add_u32 s48, s38, 15360
    buffer_load_dwordx4 v12, s[20:23], s48 offen lds
    s_add_u32 m0, s53, 2048
    s_add_u32 s48, s38, 30720
    buffer_load_dwordx4 v12, s[20:23], s48 offen lds
    s_add_u32 m0, s53, 3072
    s_add_u32 s48, s38, 46080
    buffer_load_dwordx4 v12, s[20:23], s48 offen lds
    s_add_u32 s56, s56, 1
    s_add_u32 s57, s56, s78
    s_sub_u32 s57, s57, 2
    s_and_b32 s57, s57, 7
    s_add_u32 s57, s57, 2
    s_cmp_lt_u32 s56, 2
    s_cselect_b32 s79, s56, s57
    s_lshl_b32 s57, s79, 7
    s_add_u32 s37, s58, s57
    s_mul_i32 s57, s79, 245760
    s_add_u32 s38, s59, s57
    v_mov_b32 v64, 0
    v_mov_b32 v65, 0
    v_mov_b32 v66, 0
    v_mov_b32 v67, 0
    v_mov_b32 v68, 0
    v_mov_b32 v69, 0
    v_mov_b32 v70, 0
    v_mov_b32 v71, 0
    v_mov_b32 v72, 0
    v_mov_b32 v73, 0
    v_mov_b32 v74, 0
    v_mov_b32 v75, 0
    v_mov_b32 v76, 0
    v_mov_b32 v77, 0
    v_mov_b32 v78, 0
    v_mov_b32 v79, 0
    v_mov_b32 v80, 0
    v_mov_b32 v81, 0
    v_mov_b32 v82, 0
    v_mov_b32 v83, 0
    v_mov_b32 v84, 0
    v_mov_b32 v85, 0
    v_mov_b32 v86, 0
    v_mov_b32 v87, 0
    v_mov_b32 v88, 0
    v_mov_b32 v89, 0
    v_mov_b32 v90, 0
    v_mov_b32 v91, 0
    v_mov_b32 v92, 0
    v_mov_b32 v93, 0
    v_mov_b32 v94, 0
    v_mov_b32 v95, 0
    v_mov_b32 v96, 0
    v_mov_b32 v97, 0
    v_mov_b32 v98, 0
    v_mov_b32 v99, 0
    v_mov_b32 v100, 0
    v_mov_b32 v101, 0
    v_mov_b32 v102, 0
    v_mov_b32 v103, 0
    v_mov_b32 v104, 0
    v_mov_b32 v105, 0
    v_mov_b32 v106, 0
    v_mov_b32 v107, 0
    v_mov_b32 v108, 0
    v_mov_b32 v109, 0
    v_mov_b32 v110, 0
    v_mov_b32 v111, 0
    v_mov_b32 v112, 0
    v_mov_b32 v113, 0
    v_mov_b32 v114, 0
    v_mov_b32 v115, 0
    v_mov_b32 v116, 0
    v_mov_b32 v117, 0
    v_mov_b32 v118, 0
    v_mov_b32 v119, 0
    v_mov_b32 v120, 0
    v_mov_b32 v121, 0
    v_mov_b32 v122, 0
    v_mov_b32 v123, 0
    v_mov_b32 v124, 0
    v_mov_b32 v125, 0
    v_mov_b32 v126, 0
    v_mov_b32 v127, 0
    s_lshr_b32 s41, s32, 1
    s_lshl_b32 s41, s41, 1
    s_lshl_b32 s44, s34, 2
    s_add_u32 s44, s44, s41
    s_cmp_eq_u32 s33, 3
    s_cbranch_scc1 Lk1_mainV
    s_cmp_eq_u32 s33, 1
    s_cbranch_scc0 Lk1_isK
    s_mul_i32 s68, s44, 1280
    s_add_u32 s68, s68, 0
    s_mov_b32 s49, 81920
    s_mov_b32 s70, 0x3ea52b5c
    s_branch Lk1_qk
Lk1_isK:
    s_lshr_b32 s68, s44, 3
    s_mul_i32 s68, s68, 21504
    s_and_b32 s41, s44, 7
    s_mul_i32 s41, s41, 1280
    s_add_u32 s68, s68, s41
    s_add_u32 s68, s68, 2621440
    s_mov_b32 s49, 172032
    s_mov_b32 s70, 1.0
Lk1_qk:
    s_mov_b32 s71, s70
    s_and_b32 s41, s32, 1
    s_lshl_b32 s41, s41, 4
    s_lshl_b32 s55, s46, 5
    s_add_u32 s55, s55, s41
    v_lshrrev_b32 v13, 5, v2
    v_and_b32 v3, 31, v2
    v_lshlrev_b32 v14, 4, v3
    v_lshlrev_b32 v15, 3, v3
    v_add_u32 v15, 1024, v15
    v_add_u32 v16, 0, v13
    v_add_u32 v16, s55, v16
    v_mul_u32_u24 v17, 205, v16
    v_lshrrev_b32 v17, 10, v17
    v_mul_u32_u24 v18, 5, v17
    v_sub_u32 v18, v16, v18
    v_mul_lo_u32 v17, v17, s49
    v_and_b32 v19, 1, v18
    v_lshlrev_b32 v19, 9, v19
    v_add_u32 v19, v19, v14
    v_cmp_eq_u32 vcc, 4, v18
    v_cmp_gt_u32 s[72:73], 2, v18
    s_nop 0
    v_cndmask_b32 v19, v19, v15, vcc
    v_mov_b32 v20, 10
    v_cndmask_b32 v20, v20, 2, vcc
    v_cndmask_b32 v20, v20, 1, s[72:73]
    v_add_u32 v19, v19, v17
    v_add_u32 v48, v19, v20
    v_add_u32 v16, 2, v13
    v_add_u32 v16, s55, v16
    v_mul_u32_u24 v17, 205, v16
    v_lshrrev_b32 v17, 10, v17
    v_mul_u32_u24 v18, 5, v17
    v_sub_u32 v18, v16, v18
    v_mul_lo_u32 v17, v17, s49
    v_and_b32 v19, 1, v18
    v_lshlrev_b32 v19, 9, v19
    v_add_u32 v19, v19, v14
    v_cmp_eq_u32 vcc, 4, v18
    v_cmp_gt_u32 s[72:73], 2, v18
    s_nop 0
    v_cndmask_b32 v19, v19, v15, vcc
    v_mov_b32 v20, 0
    v_cndmask_b32 v20, v20, 2, vcc
    v_cndmask_b32 v20, v20, 1, s[72:73]
    v_add_u32 v19, v19, v17
    v_add_u32 v49, v19, v20
    v_add_u32 v16, 4, v13
    v_add_u32 v16, s55, v16
    v_mul_u32_u24 v17, 205, v16
    v_lshrrev_b32 v17, 10, v17
    v_mul_u32_u24 v18, 5, v17
    v_sub_u32 v18, v16, v18
    v_mul_lo_u32 v17, v17, s49
    v_and_b32 v19, 1, v18
    v_lshlrev_b32 v19, 9, v19
    v_add_u32 v19, v19, v14
    v_cmp_eq_u32 vcc, 4, v18
    v_cmp_gt_u32 s[72:73], 2, v18
    s_nop 0
    v_cndmask_b32 v19, v19, v15, vcc
    v_mov_b32 v20, 0
    v_cndmask_b32 v20, v20, 2, vcc
    v_cndmask_b32 v20, v20, 1, s[72:73]
    v_add_u32 v19, v19, v17
    v_add_u32 v50, v19, v20
    v_add_u32 v16, 6, v13
    v_add_u32 v16, s55, v16
    v_mul_u32_u24 v17, 205, v16
    v_lshrrev_b32 v17, 10, v17
    v_mul_u32_u24 v18, 5, v17
    v_sub_u32 v18, v16, v18
    v_mul_lo_u32 v17, v17, s49
    v_and_b32 v19, 1, v18
    v_lshlrev_b32 v19, 9, v19
    v_add_u32 v19, v19, v14
    v_cmp_eq_u32 vcc, 4, v18
    v_cmp_gt_u32 s[72:73], 2, v18
    s_nop 0
    v_cndmask_b32 v19, v19, v15, vcc
    v_mov_b32 v20, 0
    v_cndmask_b32 v20, v20, 2, vcc
    v_cndmask_b32 v20, v20, 1, s[72:73]
    v_add_u32 v19, v19, v17
    v_add_u32 v51, v19, v20
    v_add_u32 v16, 8, v13
    v_add_u32 v16, s55, v16
    v_mul_u32_u24 v17, 205, v16
    v_lshrrev_b32 v17, 10, v17
    v_mul_u32_u24 v18, 5, v17
    v_sub_u32 v18, v16, v18
    v_mul_lo_u32 v17, v17, s49
    v_and_b32 v19, 1, v18
    v_lshlrev_b32 v19, 9, v19
    v_add_u32 v19, v19, v14
    v_cmp_eq_u32 vcc, 4, v18
    v_cmp_gt_u32 s[72:73], 2, v18
    s_nop 0
    v_cndmask_b32 v19, v19, v15, vcc
    v_mov_b32 v20, 0
    v_cndmask_b32 v20, v20, 2, vcc
    v_cndmask_b32 v20, v20, 1, s[72:73]
    v_add_u32 v19, v19, v17
    v_add_u32 v52, v19, v20
    v_add_u32 v16, 10, v13
    v_add_u32 v16, s55, v16
    v_mul_u32_u24 v17, 205, v16
    v_lshrrev_b32 v17, 10, v17
    v_mul_u32_u24 v18, 5, v17
    v_sub_u32 v18, v16, v18
    v_mul_lo_u32 v17, v17, s49
    v_and_b32 v19, 1, v18
    v_lshlrev_b32 v19, 9, v19
    v_add_u32 v19, v19, v14
    v_cmp_eq_u32 vcc, 4, v18
    v_cmp_gt_u32 s[72:73], 2, v18
    s_nop 0
    v_cndmask_b32 v19, v19, v15, vcc
    v_mov_b32 v20, 0
    v_cndmask_b32 v20, v20, 2, vcc
    v_cndmask_b32 v20, v20, 1, s[72:73]
    v_add_u32 v19, v19, v17
    v_add_u32 v53, v19, v20
    v_add_u32 v16, 12, v13
    v_add_u32 v16, s55, v16
    v_mul_u32_u24 v17, 205, v16
    v_lshrrev_b32 v17, 10, v17
    v_mul_u32_u24 v18, 5, v17
    v_sub_u32 v18, v16, v18
    v_mul_lo_u32 v17, v17, s49
    v_and_b32 v19, 1, v18
    v_lshlrev_b32 v19, 9, v19
    v_add_u32 v19, v19, v14
    v_cmp_eq_u32 vcc, 4, v18
    v_cmp_gt_u32 s[72:73], 2, v18
    s_nop 0
    v_cndmask_b32 v19, v19, v15, vcc
    v_mov_b32 v20, 0
    v_cndmask_b32 v20, v20, 2, vcc
    v_cndmask_b32 v20, v20, 1, s[72:73]
    v_add_u32 v19, v19, v17
    v_add_u32 v54, v19, v20
    v_add_u32 v16, 14, v13
    v_add_u32 v16, s55, v16
    v_mul_u32_u24 v17, 205, v16
    v_lshrrev_b32 v17, 10, v17
    v_mul_u32_u24 v18, 5, v17
    v_sub_u32 v18, v16, v18
    v_mul_lo_u32 v17, v17, s49
    v_and_b32 v19, 1, v18
    v_lshlrev_b32 v19, 9, v19
    v_add_u32 v19, v19, v14
    v_cmp_eq_u32 vcc, 4, v18
    v_cmp_gt_u32 s[72:73], 2, v18
    s_nop 0
    v_cndmask_b32 v19, v19, v15, vcc
    v_mov_b32 v20, 0
    v_cndmask_b32 v20, v20, 2, vcc
    v_cndmask_b32 v20, v20, 2, s[72:73]
    v_add_u32 v19, v19, v17
    v_add_u32 v55, v19, v20
    s_waitcnt vmcnt(6)
    s_barrier
    v_add_u32 v4, 0, v56
    v_add_u32 v5, 0, v57
    v_add_u32 v6, 0, v58
    v_add_u32 v7, 0, v59
    v_add_u32 v8, 0, v60
    v_add_u32 v9, 0, v61
    ds_read_b128 v[16:19], v4
    ds_read_b64_tr_b16 v[24:25], v8 offset:0
    ds_read_b64_tr_b16 v[26:27], v8 offset:1024
    ds_read_b128 v[20:23], v4 offset:4096
    ds_read_b64_tr_b16 v[28:29], v9 offset:0
    ds_read_b64_tr_b16 v[30:31], v9 offset:1024
    s_mov_b32 s50, 45056
    s_add_u32 s52, s42, 90112
    s_add_u32 s53, s43, 90112
    s_waitcnt lgkmcnt(0)
    v_mfma_f32_32x32x16_bf16 v[64:79], v[24:27], v[16:19], v[64:79]
    ds_read_b128 v[32:35], v5
    ds_read_b64_tr_b16 v[40:41], v8 offset:4096
    ds_read_b64_tr_b16 v[42:43], v8 offset:5120
    ds_read_b128 v[36:39], v5 offset:4096
    ds_read_b64_tr_b16 v[44:45], v9 offset:4096
    ds_read_b64_tr_b16 v[46:47], v9 offset:5120
    v_mfma_f32_32x32x16_bf16 v[80:95], v[28:31], v[16:19], v[80:95]
    s_add_u32 m0, s52, 0
    s_add_u32 s48, s37, 0
    buffer_load_dwordx4 v10, s[16:19], s48 offen lds
    v_mfma_f32_32x32x16_bf16 v[96:111], v[24:27], v[20:23], v[96:111]
    s_add_u32 m0, s52, 1024
    s_add_u32 s48, s37, 10240
    buffer_load_dwordx4 v11, s[16:19], s48 offen lds
    v_mfma_f32_32x32x16_bf16 v[112:127], v[28:31], v[20:23], v[112:127]
    s_add_u32 m0, s53, 0
    s_add_u32 s48, s38, 0
    buffer_load_dwordx4 v12, s[20:23], s48 offen lds
    s_waitcnt lgkmcnt(0)
    v_mfma_f32_32x32x16_bf16 v[64:79], v[40:43], v[32:35], v[64:79]
    ds_read_b128 v[16:19], v6
    ds_read_b64_tr_b16 v[24:25], v8 offset:8192
    ds_read_b64_tr_b16 v[26:27], v8 offset:9216
    ds_read_b128 v[20:23], v6 offset:4096
    ds_read_b64_tr_b16 v[28:29], v9 offset:8192
    ds_read_b64_tr_b16 v[30:31], v9 offset:9216
    v_mfma_f32_32x32x16_bf16 v[80:95], v[44:47], v[32:35], v[80:95]
    s_add_u32 m0, s53, 1024
    s_add_u32 s48, s38, 15360
    buffer_load_dwordx4 v12, s[20:23], s48 offen lds
    v_mfma_f32_32x32x16_bf16 v[96:111], v[40:43], v[36:39], v[96:111]
    s_add_u32 m0, s53, 2048
    s_add_u32 s48, s38, 30720
    buffer_load_dwordx4 v12, s[20:23], s48 offen lds
    v_mfma_f32_32x32x16_bf16 v[112:127], v[44:47], v[36:39], v[112:127]
    s_waitcnt lgkmcnt(0)
    v_mfma_f32_32x32x16_bf16 v[64:79], v[24:27], v[16:19], v[64:79]
    ds_read_b128 v[32:35], v7
    ds_read_b64_tr_b16 v[40:41], v8 offset:12288
    ds_read_b64_tr_b16 v[42:43], v8 offset:13312
    ds_read_b128 v[36:39], v7 offset:4096
    ds_read_b64_tr_b16 v[44:45], v9 offset:12288
    ds_read_b64_tr_b16 v[46:47], v9 offset:13312
    v_mfma_f32_32x32x16_bf16 v[80:95], v[28:31], v[16:19], v[80:95]
    s_add_u32 m0, s53, 3072
    s_add_u32 s48, s38, 46080
    buffer_load_dwordx4 v12, s[20:23], s48 offen lds
    s_add_u32 s56, s56, 1
    s_add_u32 s57, s56, s78
    s_sub_u32 s57, s57, 2
    s_and_b32 s57, s57, 7
    s_add_u32 s57, s57, 2
    s_cmp_lt_u32 s56, 2
    s_cselect_b32 s79, s56, s57
    s_lshl_b32 s57, s79, 7
    s_add_u32 s37, s58, s57
    s_mul_i32 s57, s79, 245760
    s_add_u32 s38, s59, s57
    v_mfma_f32_32x32x16_bf16 v[96:111], v[24:27], v[20:23], v[96:111]
    s_mov_b32 s52, s42
    s_mov_b32 s53, s43
    s_mov_b32 s40, 0
Lk1T_loop:
    v_mfma_f32_32x32x16_bf16 v[112:127], v[28:31], v[20:23], v[112:127]
    s_waitcnt vmcnt(6) lgkmcnt(0)
    s_barrier
    v_mfma_f32_32x32x16_bf16 v[64:79], v[40:43], v[32:35], v[64:79]
    v_add_u32 v4, s50, v56
    v_add_u32 v5, s50, v57
    v_add_u32 v6, s50, v58
    v_add_u32 v7, s50, v59
    v_add_u32 v8, s50, v60
    v_add_u32 v9, s50, v61
    ds_read_b128 v[16:19], v4
    ds_read_b64_tr_b16 v[24:25], v8 offset:0
    ds_read_b64_tr_b16 v[26:27], v8 offset:1024
    ds_read_b128 v[20:23], v4 offset:4096
    ds_read_b64_tr_b16 v[28:29], v9 offset:0
    ds_read_b64_tr_b16 v[30:31], v9 offset:1024
    v_mfma_f32_32x32x16_bf16 v[80:95], v[44:47], v[32:35], v[80:95]
    s_add_u32 m0, s52, 0
    s_add_u32 s48, s37, 0
    buffer_load_dwordx4 v10, s[16:19], s48 offen lds
    v_mfma_f32_32x32x16_bf16 v[96:111], v[40:43], v[36:39], v[96:111]
    s_add_u32 m0, s52, 1024
    s_add_u32 s48, s37, 10240
    buffer_load_dwordx4 v11, s[16:19], s48 offen lds
    v_mfma_f32_32x32x16_bf16 v[112:127], v[44:47], v[36:39], v[112:127]
    s_waitcnt lgkmcnt(0)
    v_mfma_f32_32x32x16_bf16 v[64:79], v[24:27], v[16:19], v[64:79]
    ds_read_b128 v[32:35], v5
    ds_read_b64_tr_b16 v[40:41], v8 offset:4096
    ds_read_b64_tr_b16 v[42:43], v8 offset:5120
    ds_read_b128 v[36:39], v5 offset:4096
    ds_read_b64_tr_b16 v[44:45], v9 offset:4096
    ds_read_b64_tr_b16 v[46:47], v9 offset:5120
    v_mfma_f32_32x32x16_bf16 v[80:95], v[28:31], v[16:19], v[80:95]
    s_add_u32 m0, s53, 0
    s_add_u32 s48, s38, 0
    buffer_load_dwordx4 v12, s[20:23], s48 offen lds
    v_mfma_f32_32x32x16_bf16 v[96:111], v[24:27], v[20:23], v[96:111]
    v_mfma_f32_32x32x16_bf16 v[112:127], v[28:31], v[20:23], v[112:127]
    s_waitcnt lgkmcnt(0)
    v_mfma_f32_32x32x16_bf16 v[64:79], v[40:43], v[32:35], v[64:79]
    ds_read_b128 v[16:19], v6
    ds_read_b64_tr_b16 v[24:25], v8 offset:8192
    ds_read_b64_tr_b16 v[26:27], v8 offset:9216
    ds_read_b128 v[20:23], v6 offset:4096
    ds_read_b64_tr_b16 v[28:29], v9 offset:8192
    ds_read_b64_tr_b16 v[30:31], v9 offset:9216
    v_mfma_f32_32x32x16_bf16 v[80:95], v[44:47], v[32:35], v[80:95]
    s_add_u32 m0, s53, 1024
    s_add_u32 s48, s38, 15360
    buffer_load_dwordx4 v12, s[20:23], s48 offen lds
    v_mfma_f32_32x32x16_bf16 v[96:111], v[40:43], v[36:39], v[96:111]
    s_add_u32 m0, s53, 2048
    s_add_u32 s48, s38, 30720
    buffer_load_dwordx4 v12, s[20:23], s48 offen lds
    v_mfma_f32_32x32x16_bf16 v[112:127], v[44:47], v[36:39], v[112:127]
    s_waitcnt lgkmcnt(0)
    v_mfma_f32_32x32x16_bf16 v[64:79], v[24:27], v[16:19], v[64:79]
    ds_read_b128 v[32:35], v7
    ds_read_b64_tr_b16 v[40:41], v8 offset:12288
    ds_read_b64_tr_b16 v[42:43], v8 offset:13312
    ds_read_b128 v[36:39], v7 offset:4096
    ds_read_b64_tr_b16 v[44:45], v9 offset:12288
    ds_read_b64_tr_b16 v[46:47], v9 offset:13312
    v_mfma_f32_32x32x16_bf16 v[80:95], v[28:31], v[16:19], v[80:95]
    s_add_u32 m0, s53, 3072
    s_add_u32 s48, s38, 46080
    buffer_load_dwordx4 v12, s[20:23], s48 offen lds
    s_add_u32 s56, s56, 1
    s_add_u32 s57, s56, s78
    s_sub_u32 s57, s57, 2
    s_and_b32 s57, s57, 7
    s_add_u32 s57, s57, 2
    s_cmp_lt_u32 s56, 2
    s_cselect_b32 s79, s56, s57
    s_lshl_b32 s57, s79, 7
    s_add_u32 s37, s58, s57
    s_mul_i32 s57, s79, 245760
    s_add_u32 s38, s59, s57
    v_mfma_f32_32x32x16_bf16 v[96:111], v[24:27], v[20:23], v[96:111]
    s_mov_b32 s51, s50
    s_add_u32 s50, s50, 45056
    s_cmp_ge_u32 s50, 135168
    s_cselect_b32 s50, 0, s50
    s_add_u32 s52, s51, s42
    s_add_u32 s53, s51, s43
    s_add_u32 s40, s40, 1
    s_cmp_lt_u32 s40, 7
    s_cbranch_scc1 Lk1T_loop
    v_mfma_f32_32x32x16_bf16 v[112:127], v[28:31], v[20:23], v[112:127]
    s_waitcnt vmcnt(6) lgkmcnt(0)
    s_barrier
    v_mfma_f32_32x32x16_bf16 v[64:79], v[40:43], v[32:35], v[64:79]
    v_add_u32 v4, s50, v56
    v_add_u32 v5, s50, v57
    v_add_u32 v6, s50, v58
    v_add_u32 v7, s50, v59
    v_add_u32 v8, s50, v60
    v_add_u32 v9, s50, v61
    ds_read_b128 v[16:19], v4
    ds_read_b64_tr_b16 v[24:25], v8 offset:0
    ds_read_b64_tr_b16 v[26:27], v8 offset:1024
    ds_read_b128 v[20:23], v4 offset:4096
    ds_read_b64_tr_b16 v[28:29], v9 offset:0
    ds_read_b64_tr_b16 v[30:31], v9 offset:1024
    v_mfma_f32_32x32x16_bf16 v[80:95], v[44:47], v[32:35], v[80:95]
    v_mfma_f32_32x32x16_bf16 v[96:111], v[40:43], v[36:39], v[96:111]
    v_mfma_f32_32x32x16_bf16 v[112:127], v[44:47], v[36:39], v[112:127]
    s_waitcnt lgkmcnt(0)
    v_mfma_f32_32x32x16_bf16 v[64:79], v[24:27], v[16:19], v[64:79]
    ds_read_b128 v[32:35], v5
    ds_read_b64_tr_b16 v[40:41], v8 offset:4096
    ds_read_b64_tr_b16 v[42:43], v8 offset:5120
    ds_read_b128 v[36:39], v5 offset:4096
    ds_read_b64_tr_b16 v[44:45], v9 offset:4096
    ds_read_b64_tr_b16 v[46:47], v9 offset:5120
    v_mfma_f32_32x32x16_bf16 v[80:95], v[28:31], v[16:19], v[80:95]
    v_mfma_f32_32x32x16_bf16 v[96:111], v[24:27], v[20:23], v[96:111]
    v_mfma_f32_32x32x16_bf16 v[112:127], v[28:31], v[20:23], v[112:127]
    s_waitcnt lgkmcnt(0)
    v_mfma_f32_32x32x16_bf16 v[64:79], v[40:43], v[32:35], v[64:79]
    ds_read_b128 v[16:19], v6
    ds_read_b64_tr_b16 v[24:25], v8 offset:8192
    ds_read_b64_tr_b16 v[26:27], v8 offset:9216
    ds_read_b128 v[20:23], v6 offset:4096
    ds_read_b64_tr_b16 v[28:29], v9 offset:8192
    ds_read_b64_tr_b16 v[30:31], v9 offset:9216
    v_mfma_f32_32x32x16_bf16 v[80:95], v[44:47], v[32:35], v[80:95]
    v_mfma_f32_32x32x16_bf16 v[96:111], v[40:43], v[36:39], v[96:111]
    v_mfma_f32_32x32x16_bf16 v[112:127], v[44:47], v[36:39], v[112:127]
    s_waitcnt lgkmcnt(0)
    v_mfma_f32_32x32x16_bf16 v[64:79], v[24:27], v[16:19], v[64:79]
    ds_read_b128 v[32:35], v7
    ds_read_b64_tr_b16 v[40:41], v8 offset:12288
    ds_read_b64_tr_b16 v[42:43], v8 offset:13312
    ds_read_b128 v[36:39], v7 offset:4096
    ds_read_b64_tr_b16 v[44:45], v9 offset:12288
    ds_read_b64_tr_b16 v[46:47], v9 offset:13312
    v_mfma_f32_32x32x16_bf16 v[80:95], v[28:31], v[16:19], v[80:95]
    s_mov_b32 s51, s50
    s_add_u32 s50, s50, 45056
    s_cmp_ge_u32 s50, 135168
    s_cselect_b32 s50, 0, s50
    s_add_u32 s52, s51, s42
    s_add_u32 s53, s51, s43
    v_mfma_f32_32x32x16_bf16 v[96:111], v[24:27], v[20:23], v[96:111]
    v_mfma_f32_32x32x16_bf16 v[112:127], v[28:31], v[20:23], v[112:127]
    s_waitcnt vmcnt(0) lgkmcnt(0)
    s_barrier
    v_mfma_f32_32x32x16_bf16 v[64:79], v[40:43], v[32:35], v[64:79]
    v_add_u32 v4, s50, v56
    v_add_u32 v5, s50, v57
    v_add_u32 v6, s50, v58
    v_add_u32 v7, s50, v59
    v_add_u32 v8, s50, v60
    v_add_u32 v9, s50, v61
    ds_read_b128 v[16:19], v4
    ds_read_b64_tr_b16 v[24:25], v8 offset:0
    ds_read_b64_tr_b16 v[26:27], v8 offset:1024
    ds_read_b128 v[20:23], v4 offset:4096
    ds_read_b64_tr_b16 v[28:29], v9 offset:0
    ds_read_b64_tr_b16 v[30:31], v9 offset:1024
    v_mfma_f32_32x32x16_bf16 v[80:95], v[44:47], v[32:35], v[80:95]
    v_mfma_f32_32x32x16_bf16 v[96:111], v[40:43], v[36:39], v[96:111]
    v_mfma_f32_32x32x16_bf16 v[112:127], v[44:47], v[36:39], v[112:127]
    s_waitcnt lgkmcnt(0)
    v_mfma_f32_32x32x16_bf16 v[64:79], v[24:27], v[16:19], v[64:79]
    ds_read_b128 v[32:35], v5
    ds_read_b64_tr_b16 v[40:41], v8 offset:4096
    ds_read_b64_tr_b16 v[42:43], v8 offset:5120
    ds_read_b128 v[36:39], v5 offset:4096
    ds_read_b64_tr_b16 v[44:45], v9 offset:4096
    ds_read_b64_tr_b16 v[46:47], v9 offset:5120
    v_mfma_f32_32x32x16_bf16 v[80:95], v[28:31], v[16:19], v[80:95]
    v_mfma_f32_32x32x16_bf16 v[96:111], v[24:27], v[20:23], v[96:111]
    v_mfma_f32_32x32x16_bf16 v[112:127], v[28:31], v[20:23], v[112:127]
    s_waitcnt lgkmcnt(0)
    v_mfma_f32_32x32x16_bf16 v[64:79], v[40:43], v[32:35], v[64:79]
    ds_read_b128 v[16:19], v6
    ds_read_b64_tr_b16 v[24:25], v8 offset:8192
    ds_read_b64_tr_b16 v[26:27], v8 offset:9216
    ds_read_b128 v[20:23], v6 offset:4096
    ds_read_b64_tr_b16 v[28:29], v9 offset:8192
    ds_read_b64_tr_b16 v[30:31], v9 offset:9216
    v_mfma_f32_32x32x16_bf16 v[80:95], v[44:47], v[32:35], v[80:95]
    v_mfma_f32_32x32x16_bf16 v[96:111], v[40:43], v[36:39], v[96:111]
    v_mfma_f32_32x32x16_bf16 v[112:127], v[44:47], v[36:39], v[112:127]
    s_waitcnt lgkmcnt(0)
    v_mfma_f32_32x32x16_bf16 v[64:79], v[24:27], v[16:19], v[64:79]
    ds_read_b128 v[32:35], v7
    ds_read_b64_tr_b16 v[40:41], v8 offset:12288
    ds_read_b64_tr_b16 v[42:43], v8 offset:13312
    ds_read_b128 v[36:39], v7 offset:4096
    ds_read_b64_tr_b16 v[44:45], v9 offset:12288
    ds_read_b64_tr_b16 v[46:47], v9 offset:13312
    v_mfma_f32_32x32x16_bf16 v[80:95], v[28:31], v[16:19], v[80:95]
    s_mov_b32 s51, s50
    s_add_u32 s50, s50, 45056
    s_cmp_ge_u32 s50, 135168
    s_cselect_b32 s50, 0, s50
    s_add_u32 s52, s51, s42
    s_add_u32 s53, s51, s43
    v_mfma_f32_32x32x16_bf16 v[96:111], v[24:27], v[20:23], v[96:111]
    v_mfma_f32_32x32x16_bf16 v[112:127], v[28:31], v[20:23], v[112:127]
    s_waitcnt vmcnt(0) lgkmcnt(0)
    s_barrier
    v_mfma_f32_32x32x16_bf16 v[64:79], v[40:43], v[32:35], v[64:79]
    v_mfma_f32_32x32x16_bf16 v[80:95], v[44:47], v[32:35], v[80:95]
    v_mfma_f32_32x32x16_bf16 v[96:111], v[40:43], v[36:39], v[96:111]
    v_mfma_f32_32x32x16_bf16 v[112:127], v[44:47], v[36:39], v[112:127]
    s_nop 15
    s_setprio 3
    v_pk_mul_f32 v[64:65], v[64:65], s[70:71]
    v_pk_mul_f32 v[66:67], v[66:67], s[70:71]
    v_cvt_pk_bf16_f32 v16, v64, v65
    v_cvt_pk_bf16_f32 v17, v66, v67
    v_pk_mul_f32 v[96:97], v[96:97], s[70:71]
    v_pk_mul_f32 v[98:99], v[98:99], s[70:71]
    v_cvt_pk_bf16_f32 v32, v96, v97
    v_cvt_pk_bf16_f32 v33, v98, v99
    v_pk_mul_f32 v[68:69], v[68:69], s[70:71]
    v_pk_mul_f32 v[70:71], v[70:71], s[70:71]
    v_cvt_pk_bf16_f32 v18, v68, v69
    v_cvt_pk_bf16_f32 v19, v70, v71
    v_pk_mul_f32 v[100:101], v[100:101], s[70:71]
    v_pk_mul_f32 v[102:103], v[102:103], s[70:71]
    v_cvt_pk_bf16_f32 v34, v100, v101
    v_cvt_pk_bf16_f32 v35, v102, v103
    v_and_b32 v56, 3, v48
    v_and_b32 v57, -4, v48
    v_cmp_eq_u32 vcc, 1, v56
    s_nop 1
    s_mov_b64 exec, vcc
    s_cbranch_execz Lqk_1_a
    buffer_store_dwordx4 v[16:19], v57, s[24:27], s68 offen sc1
    buffer_store_dwordx4 v[32:35], v57, s[24:27], s68 offen offset:1280 sc1
Lqk_1_a:
    s_mov_b64 exec, -1
    v_cmp_eq_u32 vcc, 2, v56
    s_nop 1
    s_mov_b64 exec, vcc
    s_cbranch_execz Lqk_1_b
    buffer_store_dwordx2 v[16:17], v57, s[24:27], s68 offen sc1
    buffer_store_dwordx2 v[32:33], v57, s[24:27], s68 offen offset:1280 sc1
Lqk_1_b:
    s_mov_b64 exec, -1
    v_pk_mul_f32 v[72:73], v[72:73], s[70:71]
    v_pk_mul_f32 v[74:75], v[74:75], s[70:71]
    v_cvt_pk_bf16_f32 v20, v72, v73
    v_cvt_pk_bf16_f32 v21, v74, v75
    v_pk_mul_f32 v[104:105], v[104:105], s[70:71]
    v_pk_mul_f32 v[106:107], v[106:107], s[70:71]
    v_cvt_pk_bf16_f32 v36, v104, v105
    v_cvt_pk_bf16_f32 v37, v106, v107
    v_and_b32 v56, 3, v49
    v_and_b32 v57, -4, v49
    v_cmp_eq_u32 vcc, 1, v56
    s_nop 1
    s_mov_b64 exec, vcc
    s_cbranch_execz Lqk_2_a
    buffer_store_dwordx4 v[18:21], v57, s[24:27], s68 offen sc1
    buffer_store_dwordx4 v[34:37], v57, s[24:27], s68 offen offset:1280 sc1
Lqk_2_a:
    s_mov_b64 exec, -1
    v_cmp_eq_u32 vcc, 2, v56
    s_nop 1
    s_mov_b64 exec, vcc
    s_cbranch_execz Lqk_2_b
    buffer_store_dwordx2 v[18:19], v57, s[24:27], s68 offen sc1
    buffer_store_dwordx2 v[34:35], v57, s[24:27], s68 offen offset:1280 sc1
Lqk_2_b:
    s_mov_b64 exec, -1
    v_pk_mul_f32 v[76:77], v[76:77], s[70:71]
    v_pk_mul_f32 v[78:79], v[78:79], s[70:71]
    v_cvt_pk_bf16_f32 v22, v76, v77
    v_cvt_pk_bf16_f32 v23, v78, v79
    v_pk_mul_f32 v[108:109], v[108:109], s[70:71]
    v_pk_mul_f32 v[110:111], v[110:111], s[70:71]
    v_cvt_pk_bf16_f32 v38, v108, v109
    v_cvt_pk_bf16_f32 v39, v110, v111
    v_and_b32 v56, 3, v50
    v_and_b32 v57, -4, v50
    v_cmp_eq_u32 vcc, 1, v56
    s_nop 1
    s_mov_b64 exec, vcc
    s_cbranch_execz Lqk_3_a
    buffer_store_dwordx4 v[20:23], v57, s[24:27], s68 offen sc1
    buffer_store_dwordx4 v[36:39], v57, s[24:27], s68 offen offset:1280 sc1
Lqk_3_a:
    s_mov_b64 exec, -1
    v_cmp_eq_u32 vcc, 2, v56
    s_nop 1
    s_mov_b64 exec, vcc
    s_cbranch_execz Lqk_3_b
    buffer_store_dwordx2 v[20:21], v57, s[24:27], s68 offen sc1
    buffer_store_dwordx2 v[36:37], v57, s[24:27], s68 offen offset:1280 sc1
Lqk_3_b:
    s_mov_b64 exec, -1
    v_pk_mul_f32 v[80:81], v[80:81], s[70:71]
    v_pk_mul_f32 v[82:83], v[82:83], s[70:71]
    v_cvt_pk_bf16_f32 v24, v80, v81
    v_cvt_pk_bf16_f32 v25, v82, v83
    v_pk_mul_f32 v[112:113], v[112:113], s[70:71]
    v_pk_mul_f32 v[114:115], v[114:115], s[70:71]
    v_cvt_pk_bf16_f32 v40, v112, v113
    v_cvt_pk_bf16_f32 v41, v114, v115
    v_and_b32 v56, 3, v51
    v_and_b32 v57, -4, v51
    v_cmp_eq_u32 vcc, 1, v56
    s_nop 1
    s_mov_b64 exec, vcc
    s_cbranch_execz Lqk_4_a
    buffer_store_dwordx4 v[22:25], v57, s[24:27], s68 offen sc1
    buffer_store_dwordx4 v[38:41], v57, s[24:27], s68 offen offset:1280 sc1
Lqk_4_a:
    s_mov_b64 exec, -1
    v_cmp_eq_u32 vcc, 2, v56
    s_nop 1
    s_mov_b64 exec, vcc
    s_cbranch_execz Lqk_4_b
    buffer_store_dwordx2 v[22:23], v57, s[24:27], s68 offen sc1
    buffer_store_dwordx2 v[38:39], v57, s[24:27], s68 offen offset:1280 sc1
Lqk_4_b:
    s_mov_b64 exec, -1
    v_pk_mul_f32 v[84:85], v[84:85], s[70:71]
    v_pk_mul_f32 v[86:87], v[86:87], s[70:71]
    v_cvt_pk_bf16_f32 v26, v84, v85
    v_cvt_pk_bf16_f32 v27, v86, v87
    v_pk_mul_f32 v[116:117], v[116:117], s[70:71]
    v_pk_mul_f32 v[118:119], v[118:119], s[70:71]
    v_cvt_pk_bf16_f32 v42, v116, v117
    v_cvt_pk_bf16_f32 v43, v118, v119
    v_and_b32 v56, 3, v52
    v_and_b32 v57, -4, v52
    v_cmp_eq_u32 vcc, 1, v56
    s_nop 1
    s_mov_b64 exec, vcc
    s_cbranch_execz Lqk_5_a
    buffer_store_dwordx4 v[24:27], v57, s[24:27], s68 offen sc1
    buffer_store_dwordx4 v[40:43], v57, s[24:27], s68 offen offset:1280 sc1
Lqk_5_a:
    s_mov_b64 exec, -1
    v_cmp_eq_u32 vcc, 2, v56
    s_nop 1
    s_mov_b64 exec, vcc
    s_cbranch_execz Lqk_5_b
    buffer_store_dwordx2 v[24:25], v57, s[24:27], s68 offen sc1
    buffer_store_dwordx2 v[40:41], v57, s[24:27], s68 offen offset:1280 sc1
Lqk_5_b:
    s_mov_b64 exec, -1
    v_pk_mul_f32 v[88:89], v[88:89], s[70:71]
    v_pk_mul_f32 v[90:91], v[90:91], s[70:71]
    v_cvt_pk_bf16_f32 v28, v88, v89
    v_cvt_pk_bf16_f32 v29, v90, v91
    v_pk_mul_f32 v[120:121], v[120:121], s[70:71]
    v_pk_mul_f32 v[122:123], v[122:123], s[70:71]
    v_cvt_pk_bf16_f32 v44, v120, v121
    v_cvt_pk_bf16_f32 v45, v122, v123
    v_and_b32 v56, 3, v53
    v_and_b32 v57, -4, v53
    v_cmp_eq_u32 vcc, 1, v56
    s_nop 1
    s_mov_b64 exec, vcc
    s_cbranch_execz Lqk_6_a
    buffer_store_dwordx4 v[26:29], v57, s[24:27], s68 offen sc1
    buffer_store_dwordx4 v[42:45], v57, s[24:27], s68 offen offset:1280 sc1
Lqk_6_a:
    s_mov_b64 exec, -1
    v_cmp_eq_u32 vcc, 2, v56
    s_nop 1
    s_mov_b64 exec, vcc
    s_cbranch_execz Lqk_6_b
    buffer_store_dwordx2 v[26:27], v57, s[24:27], s68 offen sc1
    buffer_store_dwordx2 v[42:43], v57, s[24:27], s68 offen offset:1280 sc1
Lqk_6_b:
    s_mov_b64 exec, -1
    v_pk_mul_f32 v[92:93], v[92:93], s[70:71]
    v_pk_mul_f32 v[94:95], v[94:95], s[70:71]
    v_cvt_pk_bf16_f32 v30, v92, v93
    v_cvt_pk_bf16_f32 v31, v94, v95
    v_pk_mul_f32 v[124:125], v[124:125], s[70:71]
    v_pk_mul_f32 v[126:127], v[126:127], s[70:71]
    v_cvt_pk_bf16_f32 v46, v124, v125
    v_cvt_pk_bf16_f32 v47, v126, v127
    v_and_b32 v56, 3, v54
    v_and_b32 v57, -4, v54
    v_cmp_eq_u32 vcc, 1, v56
    s_nop 1
    s_mov_b64 exec, vcc
    s_cbranch_execz Lqk_7_a
    buffer_store_dwordx4 v[28:31], v57, s[24:27], s68 offen sc1
    buffer_store_dwordx4 v[44:47], v57, s[24:27], s68 offen offset:1280 sc1
Lqk_7_a:
    s_mov_b64 exec, -1
    v_cmp_eq_u32 vcc, 2, v56
    s_nop 1
    s_mov_b64 exec, vcc
    s_cbranch_execz Lqk_7_b
    buffer_store_dwordx2 v[28:29], v57, s[24:27], s68 offen sc1
    buffer_store_dwordx2 v[44:45], v57, s[24:27], s68 offen offset:1280 sc1
Lqk_7_b:
    s_mov_b64 exec, -1
    v_and_b32 v56, 3, v55
    v_and_b32 v57, -4, v55
    v_cmp_eq_u32 vcc, 2, v56
    s_nop 1
    s_mov_b64 exec, vcc
    s_cbranch_execz Lqk_8_b
    buffer_store_dwordx2 v[30:31], v57, s[24:27], s68 offen sc1
    buffer_store_dwordx2 v[46:47], v57, s[24:27], s68 offen offset:1280 sc1
Lqk_8_b:
    s_mov_b64 exec, -1
    s_branch Lk1_end
Lk1_mainV:
    s_lshr_b32 s68, s44, 3
    s_mul_i32 s68, s68, 21504
    s_and_b32 s41, s44, 7
    s_mul_i32 s41, s41, 1408
    s_add_u32 s68, s68, s41
    s_add_u32 s68, s68, 2631680
    s_and_b32 s41, s32, 1
    s_lshl_b32 s41, s41, 6
    s_lshl_b32 s55, s46, 7
    s_add_u32 s55, s55, s41
    v_and_b32 v3, 31, v2
    v_lshrrev_b32 v13, 5, v2
    v_mul_u32_u24 v14, 352, v13
    s_mov_b32 s49, 172032
    v_add_u32 v16, 0, v3
    v_add_u32 v16, s55, v16
    v_mul_u32_u24 v17, 3277, v16
    v_lshrrev_b32 v17, 16, v17
    v_mul_u32_u24 v18, 20, v17
    v_sub_u32 v18, v16, v18
    v_mul_lo_u32 v17, v17, s49
    v_cmp_eq_u32 s[72:73], 0, v18
    v_mov_b32 v20, v18
    v_add_u32 v21, 12, v18
    v_cmp_lt_u32 vcc, 3, v18
    s_nop 1
    v_cndmask_b32 v20, v20, v21, vcc
    v_subrev_u32 v21, 1, v18
    v_cmp_lt_u32 vcc, 9, v18
    s_nop 1
    v_cndmask_b32 v20, v20, v21, vcc
    v_subrev_u32 v21, 8, v18
    v_cmp_lt_u32 vcc, 11, v18
    s_nop 1
    v_cndmask_b32 v20, v20, v21, vcc
    v_subrev_u32 v21, 5, v18
    v_cmp_lt_u32 vcc, 15, v18
    s_nop 1
    v_cndmask_b32 v20, v20, v21, vcc
    v_cmp_lt_u32 vcc, 19, v18
    s_nop 1
    v_cndmask_b32 v20, v20, 8, vcc
    v_cmp_lt_u32 vcc, 20, v18
    s_nop 1
    v_cndmask_b32 v20, v20, 15, vcc
    v_lshl_add_u32 v19, v20, 4, v17
    v_add_u32 v48, v19, v14
    v_add_u32 v16, 32, v3
    v_add_u32 v16, s55, v16
    v_mul_u32_u24 v17, 3277, v16
    v_lshrrev_b32 v17, 16, v17
    v_mul_u32_u24 v18, 20, v17
    v_sub_u32 v18, v16, v18
    v_mul_lo_u32 v17, v17, s49
    v_cmp_eq_u32 s[74:75], 0, v18
    v_mov_b32 v20, v18
    v_add_u32 v21, 12, v18
    v_cmp_lt_u32 vcc, 3, v18
    s_nop 1
    v_cndmask_b32 v20, v20, v21, vcc
    v_subrev_u32 v21, 1, v18
    v_cmp_lt_u32 vcc, 9, v18
    s_nop 1
    v_cndmask_b32 v20, v20, v21, vcc
    v_subrev_u32 v21, 8, v18
    v_cmp_lt_u32 vcc, 11, v18
    s_nop 1
    v_cndmask_b32 v20, v20, v21, vcc
    v_subrev_u32 v21, 5, v18
    v_cmp_lt_u32 vcc, 15, v18
    s_nop 1
    v_cndmask_b32 v20, v20, v21, vcc
    v_cmp_lt_u32 vcc, 19, v18
    s_nop 1
    v_cndmask_b32 v20, v20, 8, vcc
    v_cmp_lt_u32 vcc, 20, v18
    s_nop 1
    v_cndmask_b32 v20, v20, 15, vcc
    v_lshl_add_u32 v19, v20, 4, v17
    v_add_u32 v49, v19, v14
    s_waitcnt vmcnt(6)
    s_barrier
    v_add_u32 v4, 0, v56
    v_add_u32 v5, 0, v57
    v_add_u32 v6, 0, v58
    v_add_u32 v7, 0, v59
    v_add_u32 v8, 0, v60
    v_add_u32 v9, 0, v61
    ds_read_b128 v[16:19], v4
    ds_read_b64_tr_b16 v[24:25], v8 offset:0
    ds_read_b64_tr_b16 v[26:27], v8 offset:1024
    ds_read_b128 v[20:23], v4 offset:4096
    ds_read_b64_tr_b16 v[28:29], v9 offset:0
    ds_read_b64_tr_b16 v[30:31], v9 offset:1024
    s_mov_b32 s50, 45056
    s_add_u32 s52, s42, 90112
    s_add_u32 s53, s43, 90112
    s_waitcnt lgkmcnt(0)
    v_mfma_f32_32x32x16_bf16 v[64:79], v[16:19], v[24:27], v[64:79]
    ds_read_b128 v[32:35], v5
    ds_read_b64_tr_b16 v[40:41], v8 offset:4096
    ds_read_b64_tr_b16 v[42:43], v8 offset:5120
    ds_read_b128 v[36:39], v5 offset:4096
    ds_read_b64_tr_b16 v[44:45], v9 offset:4096
    ds_read_b64_tr_b16 v[46:47], v9 offset:5120
    v_mfma_f32_32x32x16_bf16 v[80:95], v[16:19], v[28:31], v[80:95]
    s_add_u32 m0, s52, 0
    s_add_u32 s48, s37, 0
    buffer_load_dwordx4 v10, s[16:19], s48 offen lds
    v_mfma_f32_32x32x16_bf16 v[96:111], v[20:23], v[24:27], v[96:111]
    s_add_u32 m0, s52, 1024
    s_add_u32 s48, s37, 10240
    buffer_load_dwordx4 v11, s[16:19], s48 offen lds
    v_mfma_f32_32x32x16_bf16 v[112:127], v[20:23], v[28:31], v[112:127]
    s_add_u32 m0, s53, 0
    s_add_u32 s48, s38, 0
    buffer_load_dwordx4 v12, s[20:23], s48 offen lds
    s_waitcnt lgkmcnt(0)
    v_mfma_f32_32x32x16_bf16 v[64:79], v[32:35], v[40:43], v[64:79]
    ds_read_b128 v[16:19], v6
    ds_read_b64_tr_b16 v[24:25], v8 offset:8192
    ds_read_b64_tr_b16 v[26:27], v8 offset:9216
    ds_read_b128 v[20:23], v6 offset:4096
    ds_read_b64_tr_b16 v[28:29], v9 offset:8192
    ds_read_b64_tr_b16 v[30:31], v9 offset:9216
    v_mfma_f32_32x32x16_bf16 v[80:95], v[32:35], v[44:47], v[80:95]
    s_add_u32 m0, s53, 1024
    s_add_u32 s48, s38, 15360
    buffer_load_dwordx4 v12, s[20:23], s48 offen lds
    v_mfma_f32_32x32x16_bf16 v[96:111], v[36:39], v[40:43], v[96:111]
    s_add_u32 m0, s53, 2048
    s_add_u32 s48, s38, 30720
    buffer_load_dwordx4 v12, s[20:23], s48 offen lds
    v_mfma_f32_32x32x16_bf16 v[112:127], v[36:39], v[44:47], v[112:127]
    s_waitcnt lgkmcnt(0)
    v_mfma_f32_32x32x16_bf16 v[64:79], v[16:19], v[24:27], v[64:79]
    ds_read_b128 v[32:35], v7
    ds_read_b64_tr_b16 v[40:41], v8 offset:12288
    ds_read_b64_tr_b16 v[42:43], v8 offset:13312
    ds_read_b128 v[36:39], v7 offset:4096
    ds_read_b64_tr_b16 v[44:45], v9 offset:12288
    ds_read_b64_tr_b16 v[46:47], v9 offset:13312
    v_mfma_f32_32x32x16_bf16 v[80:95], v[16:19], v[28:31], v[80:95]
    s_add_u32 m0, s53, 3072
    s_add_u32 s48, s38, 46080
    buffer_load_dwordx4 v12, s[20:23], s48 offen lds
    s_add_u32 s56, s56, 1
    s_add_u32 s57, s56, s78
    s_sub_u32 s57, s57, 2
    s_and_b32 s57, s57, 7
    s_add_u32 s57, s57, 2
    s_cmp_lt_u32 s56, 2
    s_cselect_b32 s79, s56, s57
    s_lshl_b32 s57, s79, 7
    s_add_u32 s37, s58, s57
    s_mul_i32 s57, s79, 245760
    s_add_u32 s38, s59, s57
    v_mfma_f32_32x32x16_bf16 v[96:111], v[20:23], v[24:27], v[96:111]
    s_mov_b32 s52, s42
    s_mov_b32 s53, s43
    s_mov_b32 s40, 0
Lk1N_loop:
    v_mfma_f32_32x32x16_bf16 v[112:127], v[20:23], v[28:31], v[112:127]
    s_waitcnt vmcnt(6) lgkmcnt(0)
    s_barrier
    v_mfma_f32_32x32x16_bf16 v[64:79], v[32:35], v[40:43], v[64:79]
    v_add_u32 v4, s50, v56
    v_add_u32 v5, s50, v57
    v_add_u32 v6, s50, v58
    v_add_u32 v7, s50, v59
    v_add_u32 v8, s50, v60
    v_add_u32 v9, s50, v61
    ds_read_b128 v[16:19], v4
    ds_read_b64_tr_b16 v[24:25], v8 offset:0
    ds_read_b64_tr_b16 v[26:27], v8 offset:1024
    ds_read_b128 v[20:23], v4 offset:4096
    ds_read_b64_tr_b16 v[28:29], v9 offset:0
    ds_read_b64_tr_b16 v[30:31], v9 offset:1024
    v_mfma_f32_32x32x16_bf16 v[80:95], v[32:35], v[44:47], v[80:95]
    s_add_u32 m0, s52, 0
    s_add_u32 s48, s37, 0
    buffer_load_dwordx4 v10, s[16:19], s48 offen lds
    v_mfma_f32_32x32x16_bf16 v[96:111], v[36:39], v[40:43], v[96:111]
    s_add_u32 m0, s52, 1024
    s_add_u32 s48, s37, 10240
    buffer_load_dwordx4 v11, s[16:19], s48 offen lds
    v_mfma_f32_32x32x16_bf16 v[112:127], v[36:39], v[44:47], v[112:127]
    s_waitcnt lgkmcnt(0)
    v_mfma_f32_32x32x16_bf16 v[64:79], v[16:19], v[24:27], v[64:79]
    ds_read_b128 v[32:35], v5
    ds_read_b64_tr_b16 v[40:41], v8 offset:4096
    ds_read_b64_tr_b16 v[42:43], v8 offset:5120
    ds_read_b128 v[36:39], v5 offset:4096
    ds_read_b64_tr_b16 v[44:45], v9 offset:4096
    ds_read_b64_tr_b16 v[46:47], v9 offset:5120
    v_mfma_f32_32x32x16_bf16 v[80:95], v[16:19], v[28:31], v[80:95]
    s_add_u32 m0, s53, 0
    s_add_u32 s48, s38, 0
    buffer_load_dwordx4 v12, s[20:23], s48 offen lds
    v_mfma_f32_32x32x16_bf16 v[96:111], v[20:23], v[24:27], v[96:111]
    v_mfma_f32_32x32x16_bf16 v[112:127], v[20:23], v[28:31], v[112:127]
    s_waitcnt lgkmcnt(0)
    v_mfma_f32_32x32x16_bf16 v[64:79], v[32:35], v[40:43], v[64:79]
    ds_read_b128 v[16:19], v6
    ds_read_b64_tr_b16 v[24:25], v8 offset:8192
    ds_read_b64_tr_b16 v[26:27], v8 offset:9216
    ds_read_b128 v[20:23], v6 offset:4096
    ds_read_b64_tr_b16 v[28:29], v9 offset:8192
    ds_read_b64_tr_b16 v[30:31], v9 offset:9216
    v_mfma_f32_32x32x16_bf16 v[80:95], v[32:35], v[44:47], v[80:95]
    s_add_u32 m0, s53, 1024
    s_add_u32 s48, s38, 15360
    buffer_load_dwordx4 v12, s[20:23], s48 offen lds
    v_mfma_f32_32x32x16_bf16 v[96:111], v[36:39], v[40:43], v[96:111]
    s_add_u32 m0, s53, 2048
    s_add_u32 s48, s38, 30720
    buffer_load_dwordx4 v12, s[20:23], s48 offen lds
    v_mfma_f32_32x32x16_bf16 v[112:127], v[36:39], v[44:47], v[112:127]
    s_waitcnt lgkmcnt(0)
    v_mfma_f32_32x32x16_bf16 v[64:79], v[16:19], v[24:27], v[64:79]
    ds_read_b128 v[32:35], v7
    ds_read_b64_tr_b16 v[40:41], v8 offset:12288
    ds_read_b64_tr_b16 v[42:43], v8 offset:13312
    ds_read_b128 v[36:39], v7 offset:4096
    ds_read_b64_tr_b16 v[44:45], v9 offset:12288
    ds_read_b64_tr_b16 v[46:47], v9 offset:13312
    v_mfma_f32_32x32x16_bf16 v[80:95], v[16:19], v[28:31], v[80:95]
    s_add_u32 m0, s53, 3072
    s_add_u32 s48, s38, 46080
    buffer_load_dwordx4 v12, s[20:23], s48 offen lds
    s_add_u32 s56, s56, 1
    s_add_u32 s57, s56, s78
    s_sub_u32 s57, s57, 2
    s_and_b32 s57, s57, 7
    s_add_u32 s57, s57, 2
    s_cmp_lt_u32 s56, 2
    s_cselect_b32 s79, s56, s57
    s_lshl_b32 s57, s79, 7
    s_add_u32 s37, s58, s57
    s_mul_i32 s57, s79, 245760
    s_add_u32 s38, s59, s57
    v_mfma_f32_32x32x16_bf16 v[96:111], v[20:23], v[24:27], v[96:111]
    s_mov_b32 s51, s50
    s_add_u32 s50, s50, 45056
    s_cmp_ge_u32 s50, 135168
    s_cselect_b32 s50, 0, s50
    s_add_u32 s52, s51, s42
    s_add_u32 s53, s51, s43
    s_add_u32 s40, s40, 1
    s_cmp_lt_u32 s40, 7
    s_cbranch_scc1 Lk1N_loop
    v_mfma_f32_32x32x16_bf16 v[112:127], v[20:23], v[28:31], v[112:127]
    s_waitcnt vmcnt(6) lgkmcnt(0)
    s_barrier
    v_mfma_f32_32x32x16_bf16 v[64:79], v[32:35], v[40:43], v[64:79]
    v_add_u32 v4, s50, v56
    v_add_u32 v5, s50, v57
    v_add_u32 v6, s50, v58
    v_add_u32 v7, s50, v59
    v_add_u32 v8, s50, v60
    v_add_u32 v9, s50, v61
    ds_read_b128 v[16:19], v4
    ds_read_b64_tr_b16 v[24:25], v8 offset:0
    ds_read_b64_tr_b16 v[26:27], v8 offset:1024
    ds_read_b128 v[20:23], v4 offset:4096
    ds_read_b64_tr_b16 v[28:29], v9 offset:0
    ds_read_b64_tr_b16 v[30:31], v9 offset:1024
    v_mfma_f32_32x32x16_bf16 v[80:95], v[32:35], v[44:47], v[80:95]
    v_mfma_f32_32x32x16_bf16 v[96:111], v[36:39], v[40:43], v[96:111]
    v_mfma_f32_32x32x16_bf16 v[112:127], v[36:39], v[44:47], v[112:127]
    s_waitcnt lgkmcnt(0)
    v_mfma_f32_32x32x16_bf16 v[64:79], v[16:19], v[24:27], v[64:79]
    ds_read_b128 v[32:35], v5
    ds_read_b64_tr_b16 v[40:41], v8 offset:4096
    ds_read_b64_tr_b16 v[42:43], v8 offset:5120
    ds_read_b128 v[36:39], v5 offset:4096
    ds_read_b64_tr_b16 v[44:45], v9 offset:4096
    ds_read_b64_tr_b16 v[46:47], v9 offset:5120
    v_mfma_f32_32x32x16_bf16 v[80:95], v[16:19], v[28:31], v[80:95]
    v_mfma_f32_32x32x16_bf16 v[96:111], v[20:23], v[24:27], v[96:111]
    v_mfma_f32_32x32x16_bf16 v[112:127], v[20:23], v[28:31], v[112:127]
    s_waitcnt lgkmcnt(0)
    v_mfma_f32_32x32x16_bf16 v[64:79], v[32:35], v[40:43], v[64:79]
    ds_read_b128 v[16:19], v6
    ds_read_b64_tr_b16 v[24:25], v8 offset:8192
    ds_read_b64_tr_b16 v[26:27], v8 offset:9216
    ds_read_b128 v[20:23], v6 offset:4096
    ds_read_b64_tr_b16 v[28:29], v9 offset:8192
    ds_read_b64_tr_b16 v[30:31], v9 offset:9216
    v_mfma_f32_32x32x16_bf16 v[80:95], v[32:35], v[44:47], v[80:95]
    v_mfma_f32_32x32x16_bf16 v[96:111], v[36:39], v[40:43], v[96:111]
    v_mfma_f32_32x32x16_bf16 v[112:127], v[36:39], v[44:47], v[112:127]
    s_waitcnt lgkmcnt(0)
    v_mfma_f32_32x32x16_bf16 v[64:79], v[16:19], v[24:27], v[64:79]
    ds_read_b128 v[32:35], v7
    ds_read_b64_tr_b16 v[40:41], v8 offset:12288
    ds_read_b64_tr_b16 v[42:43], v8 offset:13312
    ds_read_b128 v[36:39], v7 offset:4096
    ds_read_b64_tr_b16 v[44:45], v9 offset:12288
    ds_read_b64_tr_b16 v[46:47], v9 offset:13312
    v_mfma_f32_32x32x16_bf16 v[80:95], v[16:19], v[28:31], v[80:95]
    s_mov_b32 s51, s50
    s_add_u32 s50, s50, 45056
    s_cmp_ge_u32 s50, 135168
    s_cselect_b32 s50, 0, s50
    s_add_u32 s52, s51, s42
    s_add_u32 s53, s51, s43
    v_mfma_f32_32x32x16_bf16 v[96:111], v[20:23], v[24:27], v[96:111]
    v_mfma_f32_32x32x16_bf16 v[112:127], v[20:23], v[28:31], v[112:127]
    s_waitcnt vmcnt(0) lgkmcnt(0)
    s_barrier
    v_mfma_f32_32x32x16_bf16 v[64:79], v[32:35], v[40:43], v[64:79]
    v_add_u32 v4, s50, v56
    v_add_u32 v5, s50, v57
    v_add_u32 v6, s50, v58
    v_add_u32 v7, s50, v59
    v_add_u32 v8, s50, v60
    v_add_u32 v9, s50, v61
    ds_read_b128 v[16:19], v4
    ds_read_b64_tr_b16 v[24:25], v8 offset:0
    ds_read_b64_tr_b16 v[26:27], v8 offset:1024
    ds_read_b128 v[20:23], v4 offset:4096
    ds_read_b64_tr_b16 v[28:29], v9 offset:0
    ds_read_b64_tr_b16 v[30:31], v9 offset:1024
    v_mfma_f32_32x32x16_bf16 v[80:95], v[32:35], v[44:47], v[80:95]
    v_mfma_f32_32x32x16_bf16 v[96:111], v[36:39], v[40:43], v[96:111]
    v_mfma_f32_32x32x16_bf16 v[112:127], v[36:39], v[44:47], v[112:127]
    s_waitcnt lgkmcnt(0)
    v_mfma_f32_32x32x16_bf16 v[64:79], v[16:19], v[24:27], v[64:79]
    ds_read_b128 v[32:35], v5
    ds_read_b64_tr_b16 v[40:41], v8 offset:4096
    ds_read_b64_tr_b16 v[42:43], v8 offset:5120
    ds_read_b128 v[36:39], v5 offset:4096
    ds_read_b64_tr_b16 v[44:45], v9 offset:4096
    ds_read_b64_tr_b16 v[46:47], v9 offset:5120
    v_mfma_f32_32x32x16_bf16 v[80:95], v[16:19], v[28:31], v[80:95]
    v_mfma_f32_32x32x16_bf16 v[96:111], v[20:23], v[24:27], v[96:111]
    v_mfma_f32_32x32x16_bf16 v[112:127], v[20:23], v[28:31], v[112:127]
    s_waitcnt lgkmcnt(0)
    v_mfma_f32_32x32x16_bf16 v[64:79], v[32:35], v[40:43], v[64:79]
    ds_read_b128 v[16:19], v6
    ds_read_b64_tr_b16 v[24:25], v8 offset:8192
    ds_read_b64_tr_b16 v[26:27], v8 offset:9216
    ds_read_b128 v[20:23], v6 offset:4096
    ds_read_b64_tr_b16 v[28:29], v9 offset:8192
    ds_read_b64_tr_b16 v[30:31], v9 offset:9216
    v_mfma_f32_32x32x16_bf16 v[80:95], v[32:35], v[44:47], v[80:95]
    v_mfma_f32_32x32x16_bf16 v[96:111], v[36:39], v[40:43], v[96:111]
    v_mfma_f32_32x32x16_bf16 v[112:127], v[36:39], v[44:47], v[112:127]
    s_waitcnt lgkmcnt(0)
    v_mfma_f32_32x32x16_bf16 v[64:79], v[16:19], v[24:27], v[64:79]
    ds_read_b128 v[32:35], v7
    ds_read_b64_tr_b16 v[40:41], v8 offset:12288
    ds_read_b64_tr_b16 v[42:43], v8 offset:13312
    ds_read_b128 v[36:39], v7 offset:4096
    ds_read_b64_tr_b16 v[44:45], v9 offset:12288
    ds_read_b64_tr_b16 v[46:47], v9 offset:13312
    v_mfma_f32_32x32x16_bf16 v[80:95], v[16:19], v[28:31], v[80:95]
    s_mov_b32 s51, s50
    s_add_u32 s50, s50, 45056
    s_cmp_ge_u32 s50, 135168
    s_cselect_b32 s50, 0, s50
    s_add_u32 s52, s51, s42
    s_add_u32 s53, s51, s43
    v_mfma_f32_32x32x16_bf16 v[96:111], v[20:23], v[24:27], v[96:111]
    v_mfma_f32_32x32x16_bf16 v[112:127], v[20:23], v[28:31], v[112:127]
    s_waitcnt vmcnt(0) lgkmcnt(0)
    s_barrier
    v_mfma_f32_32x32x16_bf16 v[64:79], v[32:35], v[40:43], v[64:79]
    v_mfma_f32_32x32x16_bf16 v[80:95], v[32:35], v[44:47], v[80:95]
    v_mfma_f32_32x32x16_bf16 v[96:111], v[36:39], v[40:43], v[96:111]
    v_mfma_f32_32x32x16_bf16 v[112:127], v[36:39], v[44:47], v[112:127]
    s_nop 15
    s_setprio 3
    v_cvt_pk_bf16_f32 v32, v64, v65
    v_cvt_pk_bf16_f32 v33, v66, v67
    v_cvt_pk_bf16_f32 v34, v68, v69
    v_cvt_pk_bf16_f32 v35, v70, v71
    buffer_store_dwordx4 v[32:35], v48, s[24:27], s68 offen offset:0 sc1
    v_cvt_pk_bf16_f32 v36, v72, v73
    v_cvt_pk_bf16_f32 v37, v74, v75
    v_cvt_pk_bf16_f32 v38, v76, v77
    v_cvt_pk_bf16_f32 v39, v78, v79
    buffer_store_dwordx4 v[36:39], v48, s[24:27], s68 offen offset:704 sc1
    v_cvt_pk_bf16_f32 v40, v96, v97
    v_cvt_pk_bf16_f32 v41, v98, v99
    v_cvt_pk_bf16_f32 v42, v100, v101
    v_cvt_pk_bf16_f32 v43, v102, v103
    buffer_store_dwordx4 v[40:43], v48, s[24:27], s68 offen offset:1408 sc1
    v_cvt_pk_bf16_f32 v44, v104, v105
    v_cvt_pk_bf16_f32 v45, v106, v107
    v_cvt_pk_bf16_f32 v46, v108, v109
    v_cvt_pk_bf16_f32 v47, v110, v111
    buffer_store_dwordx4 v[44:47], v48, s[24:27], s68 offen offset:2112 sc1
    v_cvt_pk_bf16_f32 v32, v80, v81
    v_cvt_pk_bf16_f32 v33, v82, v83
    v_cvt_pk_bf16_f32 v34, v84, v85
    v_cvt_pk_bf16_f32 v35, v86, v87
    buffer_store_dwordx4 v[32:35], v49, s[24:27], s68 offen offset:0 sc1
    v_cvt_pk_bf16_f32 v36, v88, v89
    v_cvt_pk_bf16_f32 v37, v90, v91
    v_cvt_pk_bf16_f32 v38, v92, v93
    v_cvt_pk_bf16_f32 v39, v94, v95
    buffer_store_dwordx4 v[36:39], v49, s[24:27], s68 offen offset:704 sc1
    v_cvt_pk_bf16_f32 v40, v112, v113
    v_cvt_pk_bf16_f32 v41, v114, v115
    v_cvt_pk_bf16_f32 v42, v116, v117
    v_cvt_pk_bf16_f32 v43, v118, v119
    buffer_store_dwordx4 v[40:43], v49, s[24:27], s68 offen offset:1408 sc1
    v_cvt_pk_bf16_f32 v44, v120, v121
    v_cvt_pk_bf16_f32 v45, v122, v123
    v_cvt_pk_bf16_f32 v46, v124, v125
    v_cvt_pk_bf16_f32 v47, v126, v127
    buffer_store_dwordx4 v[44:47], v49, s[24:27], s68 offen offset:2112 sc1
    s_branch Lk1_end
Lk1_gate:
    s_mov_b32 s28, s12
    s_and_b32 s29, s13, 0xffff
    s_mov_b32 s30, 1280
    s_mov_b32 s31, 0x00020000
    s_mul_i32 s41, s32, 320
    s_add_u32 m0, s41, 135168
    v_lshlrev_b32 v12, 4, v2
    v_cmp_gt_u32 vcc, 20, v2
    s_and_saveexec_b64 s[76:77], vcc
    buffer_load_dwordx4 v12, s[28:31], s41 offen lds
    s_mov_b64 exec, s[76:77]
    s_add_u32 s52, s42, 0
    s_add_u32 m0, s52, 0
    s_add_u32 s48, s37, 0
    buffer_load_dwordx4 v10, s[16:19], s48 offen lds
    s_add_u32 m0, s52, 1024
    s_add_u32 s48, s37, 10240
    buffer_load_dwordx4 v11, s[16:19], s48 offen lds
    s_add_u32 s56, s56, 1
    s_add_u32 s57, s56, s78
    s_sub_u32 s57, s57, 2
    s_and_b32 s57, s57, 7
    s_add_u32 s57, s57, 2
    s_cmp_lt_u32 s56, 2
    s_cselect_b32 s79, s56, s57
    s_lshl_b32 s57, s79, 7
    s_add_u32 s37, s58, s57
    s_barrier
    s_add_u32 s52, s42, 45056
    s_add_u32 m0, s52, 0
    s_add_u32 s48, s37, 0
    buffer_load_dwordx4 v10, s[16:19], s48 offen lds
    s_add_u32 m0, s52, 1024
    s_add_u32 s48, s37, 10240
    buffer_load_dwordx4 v11, s[16:19], s48 offen lds
    s_add_u32 s56, s56, 1
    s_add_u32 s57, s56, s78
    s_sub_u32 s57, s57, 2
    s_and_b32 s57, s57, 7
    s_add_u32 s57, s57, 2
    s_cmp_lt_u32 s56, 2
    s_cselect_b32 s79, s56, s57
    s_lshl_b32 s57, s79, 7
    s_add_u32 s37, s58, s57
    s_lshl_b32 s41, s32, 12
    v_and_b32 v3, 31, v2
    v_lshrrev_b32 v13, 5, v2
    v_bfe_u32 v14, v2, 1, 3
    v_xor_b32 v14, v13, v14
    v_lshlrev_b32 v14, 4, v14
    v_lshl_add_u32 v14, v3, 7, v14
    v_add_u32 v56, s41, v14
    v_xor_b32 v57, 32, v56
    v_xor_b32 v58, 64, v56
    v_xor_b32 v59, 96, v56
    v_lshlrev_b32 v9, 4, v13
    v_add_u32 v62, 135168, v9
    s_lshl_b32 s57, s69, 7
    v_add_u32 v9, s57, v62
    v_mov_b32 v60, 0
    s_mov_b32 s43, 0
    v_mov_b32 v64, 0
    v_mov_b32 v65, 0
    v_mov_b32 v66, 0
    v_mov_b32 v67, 0
    v_mov_b32 v68, 0
    v_mov_b32 v69, 0
    v_mov_b32 v70, 0
    v_mov_b32 v71, 0
    v_mov_b32 v72, 0
    v_mov_b32 v73, 0
    v_mov_b32 v74, 0
    v_mov_b32 v75, 0
    v_mov_b32 v76, 0
    v_mov_b32 v77, 0
    v_mov_b32 v78, 0
    v_mov_b32 v79, 0
    s_waitcnt vmcnt(2)
    s_barrier
    s_add_u32 s52, s42, 90112
    s_add_u32 m0, s52, 0
    s_add_u32 s48, s37, 0
    buffer_load_dwordx4 v10, s[16:19], s48 offen lds
    s_add_u32 m0, s52, 1024
    s_add_u32 s48, s37, 10240
    buffer_load_dwordx4 v11, s[16:19], s48 offen lds
    s_add_u32 s56, s56, 1
    s_add_u32 s57, s56, s78
    s_sub_u32 s57, s57, 2
    s_and_b32 s57, s57, 7
    s_add_u32 s57, s57, 2
    s_cmp_lt_u32 s56, 2
    s_cselect_b32 s79, s56, s57
    s_lshl_b32 s57, s79, 7
    s_add_u32 s37, s58, s57
    v_add_u32 v4, 0, v56
    v_add_u32 v5, 0, v57
    v_add_u32 v6, 0, v58
    v_add_u32 v7, 0, v59
    ds_read_b128 v[16:19], v4
    ds_read_b128 v[20:23], v9 offset:0
    s_mov_b32 s40, 0
    s_mov_b32 s50, 45056
    s_mov_b32 s51, 0
Lk1g_loop:
    ds_read_b128 v[32:35], v5
    ds_read_b128 v[36:39], v9 offset:32
    s_waitcnt lgkmcnt(2)
    v_mfma_f32_32x32x16_bf16 v[64:79], v[20:23], v[16:19], v[64:79]
    ds_read_b128 v[16:19], v6
    ds_read_b128 v[20:23], v9 offset:64
    s_waitcnt lgkmcnt(2)
    v_mfma_f32_32x32x16_bf16 v[64:79], v[36:39], v[32:35], v[64:79]
    ds_read_b128 v[32:35], v7
    ds_read_b128 v[36:39], v9 offset:96
    s_add_u32 s69, s69, 1
    s_add_u32 s57, s69, s78
    s_sub_u32 s57, s57, 2
    s_and_b32 s57, s57, 7
    s_add_u32 s57, s57, 2
    s_cmp_lt_u32 s69, 2
    s_cselect_b32 s57, s69, s57
    s_lshl_b32 s57, s57, 7
    v_add_u32 v9, s57, v62
    s_waitcnt lgkmcnt(2)
    v_mfma_f32_32x32x16_bf16 v[64:79], v[20:23], v[16:19], v[64:79]
    s_cmp_lt_u32 s40, 8
    s_cbranch_scc1 Lk1g_a
    s_waitcnt vmcnt(0)
Lk1g_a:
    s_waitcnt vmcnt(2) lgkmcnt(0)
    s_barrier
    v_add_u32 v4, s50, v56
    v_add_u32 v5, s50, v57
    v_add_u32 v6, s50, v58
    v_add_u32 v7, s50, v59
    v_mfma_f32_32x32x16_bf16 v[64:79], v[36:39], v[32:35], v[64:79]
    ds_read_b128 v[16:19], v4
    ds_read_b128 v[20:23], v9 offset:0
    s_cmp_lt_u32 s40, 7
    s_cbranch_scc0 Lk1g_b
    s_add_u32 s52, s51, s42
    s_add_u32 m0, s52, 0
    s_add_u32 s48, s37, 0
    buffer_load_dwordx4 v10, s[16:19], s48 offen lds
    s_add_u32 m0, s52, 1024
    s_add_u32 s48, s37, 10240
    buffer_load_dwordx4 v11, s[16:19], s48 offen lds
    s_add_u32 s56, s56, 1
    s_add_u32 s57, s56, s78
    s_sub_u32 s57, s57, 2
    s_and_b32 s57, s57, 7
    s_add_u32 s57, s57, 2
    s_cmp_lt_u32 s56, 2
    s_cselect_b32 s79, s56, s57
    s_lshl_b32 s57, s79, 7
    s_add_u32 s37, s58, s57
Lk1g_b:
    s_mov_b32 s51, s50
    s_add_u32 s50, s50, 45056
    s_cmp_ge_u32 s50, 135168
    s_cselect_b32 s50, 0, s50
    s_add_u32 s40, s40, 1
    s_cmp_lt_u32 s40, 10
    s_cbranch_scc1 Lk1g_loop
    s_waitcnt lgkmcnt(0)
    s_nop 15
    v_mul_f32 v16, 0xbfb8aa3b, v64
    v_exp_f32 v16, v16
    s_nop 0
    v_add_f32 v16, 1.0, v16
    v_rcp_f32 v16, v16
    s_lshl_b32 s44, s34, 2
    s_add_u32 s44, s44, s32
    s_lshl_b32 s44, s44, 7
    s_add_u32 s44, s44, 20971520
    v_lshlrev_b32 v17, 2, v2
    v_cmp_gt_u32 vcc, 32, v2
    s_and_saveexec_b64 s[76:77], vcc
    buffer_store_dword v16, v17, s[24:27], s44 offen sc1
    s_mov_b64 exec, s[76:77]
    s_branch Lk1_end
Lk1_R:
    s_mov_b32 s20, s8
    s_and_b32 s21, s9, 0xffff
    s_mov_b32 s22, 1966080
    s_mov_b32 s23, 0x00020000
    s_mov_b32 s28, s10
    s_and_b32 s29, s11, 0xffff
    s_mov_b32 s30, 3072
    s_mov_b32 s31, 0x00020000
    s_sub_u32 s47, s32, 4
    s_mul_i32 s41, s35, 192
    v_lshrrev_b32 v3, 5, v2
    v_lshlrev_b32 v3, 4, v3
    buffer_load_dwordx4 v[112:115], v3, s[28:31], s41 offen
    buffer_load_dwordx4 v[116:119], v3, s[28:31], s41 offen offset:32
    buffer_load_dwordx4 v[120:123], v3, s[28:31], s41 offen offset:64
    buffer_load_dwordx4 v[124:127], v3, s[28:31], s41 offen offset:96
    buffer_load_dwordx4 v[48:51], v3, s[28:31], s41 offen offset:128
    buffer_load_dwordx4 v[52:55], v3, s[28:31], s41 offen offset:160
    s_mul_i32 s41, s47, 192
    s_add_u32 s41, s41, 0
    v_add_u32 v13, s41, v2
    v_mul_u32_u24 v14, 5462, v13
    v_lshrrev_b32 v14, 16, v14
    v_mul_u32_u24 v15, 12, v14
    v_sub_u32 v15, v13, v15
    v_mul_u32_u24 v14, 3072, v14
    v_lshl_add_u32 v12, v15, 4, v14
    s_mul_i32 s41, s47, 192
    s_add_u32 s41, s41, 64
    v_add_u32 v13, s41, v2
    v_mul_u32_u24 v14, 5462, v13
    v_lshrrev_b32 v14, 16, v14
    v_mul_u32_u24 v15, 12, v14
    v_sub_u32 v15, v13, v15
    v_mul_u32_u24 v14, 3072, v14
    v_lshl_add_u32 v62, v15, 4, v14
    s_mul_i32 s41, s47, 192
    s_add_u32 s41, s41, 128
    v_add_u32 v13, s41, v2
    v_mul_u32_u24 v14, 5462, v13
    v_lshrrev_b32 v14, 16, v14
    v_mul_u32_u24 v15, 12, v14
    v_sub_u32 v15, v13, v15
    v_mul_u32_u24 v14, 3072, v14
    v_lshl_add_u32 v63, v15, 4, v14
    s_mul_i32 s59, s35, 192
    s_mul_i32 s57, s79, 196608
    s_add_u32 s38, s59, s57
    s_mul_i32 s43, s47, 3072
    s_add_u32 s43, s43, 32768
    s_add_u32 s52, s42, 0
    s_add_u32 s53, s43, 0
    s_add_u32 m0, s52, 0
    s_add_u32 s48, s37, 0
    buffer_load_dwordx4 v10, s[16:19], s48 offen lds
    s_add_u32 m0, s52, 1024
    s_add_u32 s48, s37, 10240
    buffer_load_dwordx4 v11, s[16:19], s48 offen lds
    s_add_u32 m0, s53, 0
    s_nop 0
    buffer_load_dwordx4 v12, s[20:23], s38 offen lds
    s_add_u32 m0, s53, 1024
    s_nop 0
    buffer_load_dwordx4 v62, s[20:23], s38 offen lds
    s_add_u32 m0, s53, 2048
    s_nop 0
    buffer_load_dwordx4 v63, s[20:23], s38 offen lds
    s_add_u32 s56, s56, 1
    s_add_u32 s57, s56, s78
    s_sub_u32 s57, s57, 2
    s_and_b32 s57, s57, 7
    s_add_u32 s57, s57, 2
    s_cmp_lt_u32 s56, 2
    s_cselect_b32 s79, s56, s57
    s_lshl_b32 s57, s79, 7
    s_add_u32 s37, s58, s57
    s_mul_i32 s57, s79, 196608
    s_add_u32 s38, s59, s57
    s_barrier
    s_lshl_b32 s41, s47, 12
    v_and_b32 v3, 31, v2
    v_lshrrev_b32 v13, 5, v2
    v_bfe_u32 v14, v2, 1, 3
    v_xor_b32 v14, v13, v14
    v_lshlrev_b32 v14, 4, v14
    v_lshl_add_u32 v14, v3, 7, v14
    v_add_u32 v56, s41, v14
    v_xor_b32 v57, 32, v56
    v_xor_b32 v58, 64, v56
    v_xor_b32 v59, 96, v56
    v_bfe_u32 v14, v2, 2, 2
    v_lshl_add_u32 v15, v13, 3, v14
    v_mul_u32_u24 v15, 192, v15
    v_bfe_u32 v3, v2, 4, 1
    v_lshl_add_u32 v15, v3, 5, v15
    v_and_b32 v3, 3, v2
    v_lshrrev_b32 v1, 1, v3
    v_and_b32 v3, 1, v3
    v_lshl_or_b32 v3, v3, 1, v1
    v_lshl_add_u32 v15, v3, 3, v15
    v_add_u32 v60, 32768, v15
    s_add_u32 s52, s42, 45056
    s_add_u32 s53, s43, 45056
    s_add_u32 m0, s52, 0
    s_add_u32 s48, s37, 0
    buffer_load_dwordx4 v10, s[16:19], s48 offen lds
    s_add_u32 m0, s52, 1024
    s_add_u32 s48, s37, 10240
    buffer_load_dwordx4 v11, s[16:19], s48 offen lds
    s_add_u32 m0, s53, 0
    s_nop 0
    buffer_load_dwordx4 v12, s[20:23], s38 offen lds
    s_add_u32 m0, s53, 1024
    s_nop 0
    buffer_load_dwordx4 v62, s[20:23], s38 offen lds
    s_add_u32 m0, s53, 2048
    s_nop 0
    buffer_load_dwordx4 v63, s[20:23], s38 offen lds
    s_add_u32 s56, s56, 1
    s_add_u32 s57, s56, s78
    s_sub_u32 s57, s57, 2
    s_and_b32 s57, s57, 7
    s_add_u32 s57, s57, 2
    s_cmp_lt_u32 s56, 2
    s_cselect_b32 s79, s56, s57
    s_lshl_b32 s57, s79, 7
    s_add_u32 s37, s58, s57
    s_mul_i32 s57, s79, 196608
    s_add_u32 s38, s59, s57
    s_waitcnt vmcnt(10)
    v_lshlrev_b32 v64, 16, v112
    v_and_b32 v65, 0xffff0000, v112
    v_lshlrev_b32 v66, 16, v113
    v_and_b32 v67, 0xffff0000, v113
    v_lshlrev_b32 v68, 16, v114
    v_and_b32 v69, 0xffff0000, v114
    v_lshlrev_b32 v70, 16, v115
    v_and_b32 v71, 0xffff0000, v115
    v_lshlrev_b32 v72, 16, v116
    v_and_b32 v73, 0xffff0000, v116
    v_lshlrev_b32 v74, 16, v117
    v_and_b32 v75, 0xffff0000, v117
    v_lshlrev_b32 v76, 16, v118
    v_and_b32 v77, 0xffff0000, v118
    v_lshlrev_b32 v78, 16, v119
    v_and_b32 v79, 0xffff0000, v119
    v_lshlrev_b32 v80, 16, v120
    v_and_b32 v81, 0xffff0000, v120
    v_lshlrev_b32 v82, 16, v121
    v_and_b32 v83, 0xffff0000, v121
    v_lshlrev_b32 v84, 16, v122
    v_and_b32 v85, 0xffff0000, v122
    v_lshlrev_b32 v86, 16, v123
    v_and_b32 v87, 0xffff0000, v123
    v_lshlrev_b32 v88, 16, v124
    v_and_b32 v89, 0xffff0000, v124
    v_lshlrev_b32 v90, 16, v125
    v_and_b32 v91, 0xffff0000, v125
    v_lshlrev_b32 v92, 16, v126
    v_and_b32 v93, 0xffff0000, v126
    v_lshlrev_b32 v94, 16, v127
    v_and_b32 v95, 0xffff0000, v127
    v_lshlrev_b32 v96, 16, v48
    v_and_b32 v97, 0xffff0000, v48
    v_lshlrev_b32 v98, 16, v49
    v_and_b32 v99, 0xffff0000, v49
    v_lshlrev_b32 v100, 16, v50
    v_and_b32 v101, 0xffff0000, v50
    v_lshlrev_b32 v102, 16, v51
    v_and_b32 v103, 0xffff0000, v51
    v_lshlrev_b32 v104, 16, v52
    v_and_b32 v105, 0xffff0000, v52
    v_lshlrev_b32 v106, 16, v53
    v_and_b32 v107, 0xffff0000, v53
    v_lshlrev_b32 v108, 16, v54
    v_and_b32 v109, 0xffff0000, v54
    v_lshlrev_b32 v110, 16, v55
    v_and_b32 v111, 0xffff0000, v55
    s_waitcnt vmcnt(5)
    s_barrier
    v_add_u32 v4, 0, v56
    v_add_u32 v5, 0, v57
    v_add_u32 v6, 0, v58
    v_add_u32 v7, 0, v59
    v_add_u32 v8, 0, v60
    ds_read_b128 v[16:19], v4
    ds_read_b64_tr_b16 v[20:21], v8 offset:0
    ds_read_b64_tr_b16 v[22:23], v8 offset:768
    ds_read_b64_tr_b16 v[24:25], v8 offset:64
    ds_read_b64_tr_b16 v[26:27], v8 offset:832
    ds_read_b64_tr_b16 v[28:29], v8 offset:128
    ds_read_b64_tr_b16 v[30:31], v8 offset:896
    s_mov_b32 s50, 45056
    s_add_u32 s52, s42, 90112
    s_add_u32 s53, s43, 90112
    s_waitcnt lgkmcnt(0)
    v_mfma_f32_32x32x16_bf16 v[64:79], v[20:23], v[16:19], v[64:79]
    ds_read_b128 v[32:35], v5
    ds_read_b64_tr_b16 v[36:37], v8 offset:3072
    ds_read_b64_tr_b16 v[38:39], v8 offset:3840
    ds_read_b64_tr_b16 v[40:41], v8 offset:3136
    ds_read_b64_tr_b16 v[42:43], v8 offset:3904
    ds_read_b64_tr_b16 v[44:45], v8 offset:3200
    ds_read_b64_tr_b16 v[46:47], v8 offset:3968
    v_mfma_f32_32x32x16_bf16 v[80:95], v[24:27], v[16:19], v[80:95]
    s_add_u32 m0, s52, 0
    s_add_u32 s48, s37, 0
    buffer_load_dwordx4 v10, s[16:19], s48 offen lds
    s_add_u32 m0, s52, 1024
    s_add_u32 s48, s37, 10240
    buffer_load_dwordx4 v11, s[16:19], s48 offen lds
    v_mfma_f32_32x32x16_bf16 v[96:111], v[28:31], v[16:19], v[96:111]
    s_add_u32 m0, s53, 0
    s_nop 0
    buffer_load_dwordx4 v12, s[20:23], s38 offen lds
    s_waitcnt lgkmcnt(0)
    v_mfma_f32_32x32x16_bf16 v[64:79], v[36:39], v[32:35], v[64:79]
    ds_read_b128 v[16:19], v6
    ds_read_b64_tr_b16 v[20:21], v8 offset:6144
    ds_read_b64_tr_b16 v[22:23], v8 offset:6912
    ds_read_b64_tr_b16 v[24:25], v8 offset:6208
    ds_read_b64_tr_b16 v[26:27], v8 offset:6976
    ds_read_b64_tr_b16 v[28:29], v8 offset:6272
    ds_read_b64_tr_b16 v[30:31], v8 offset:7040
    v_mfma_f32_32x32x16_bf16 v[80:95], v[40:43], v[32:35], v[80:95]
    s_add_u32 m0, s53, 1024
    s_nop 0
    buffer_load_dwordx4 v62, s[20:23], s38 offen lds
    v_mfma_f32_32x32x16_bf16 v[96:111], v[44:47], v[32:35], v[96:111]
    s_waitcnt lgkmcnt(0)
    v_mfma_f32_32x32x16_bf16 v[64:79], v[20:23], v[16:19], v[64:79]
    ds_read_b128 v[32:35], v7
    ds_read_b64_tr_b16 v[36:37], v8 offset:9216
    ds_read_b64_tr_b16 v[38:39], v8 offset:9984
    ds_read_b64_tr_b16 v[40:41], v8 offset:9280
    ds_read_b64_tr_b16 v[42:43], v8 offset:10048
    ds_read_b64_tr_b16 v[44:45], v8 offset:9344
    ds_read_b64_tr_b16 v[46:47], v8 offset:10112
    v_mfma_f32_32x32x16_bf16 v[80:95], v[24:27], v[16:19], v[80:95]
    s_add_u32 m0, s53, 2048
    s_nop 0
    buffer_load_dwordx4 v63, s[20:23], s38 offen lds
    s_add_u32 s56, s56, 1
    s_add_u32 s57, s56, s78
    s_sub_u32 s57, s57, 2
    s_and_b32 s57, s57, 7
    s_add_u32 s57, s57, 2
    s_cmp_lt_u32 s56, 2
    s_cselect_b32 s79, s56, s57
    s_lshl_b32 s57, s79, 7
    s_add_u32 s37, s58, s57
    s_mul_i32 s57, s79, 196608
    s_add_u32 s38, s59, s57
    s_mov_b32 s52, s42
    s_mov_b32 s53, s43
    s_mov_b32 s40, 0
Lk1R_loop:
    v_mfma_f32_32x32x16_bf16 v[96:111], v[28:31], v[16:19], v[96:111]
    s_waitcnt vmcnt(5) lgkmcnt(0)
    s_barrier
    v_mfma_f32_32x32x16_bf16 v[64:79], v[36:39], v[32:35], v[64:79]
    v_add_u32 v4, s50, v56
    v_add_u32 v5, s50, v57
    v_add_u32 v6, s50, v58
    v_add_u32 v7, s50, v59
    v_add_u32 v8, s50, v60
    ds_read_b128 v[16:19], v4
    ds_read_b64_tr_b16 v[20:21], v8 offset:0
    ds_read_b64_tr_b16 v[22:23], v8 offset:768
    ds_read_b64_tr_b16 v[24:25], v8 offset:64
    ds_read_b64_tr_b16 v[26:27], v8 offset:832
    ds_read_b64_tr_b16 v[28:29], v8 offset:128
    ds_read_b64_tr_b16 v[30:31], v8 offset:896
    v_mfma_f32_32x32x16_bf16 v[80:95], v[40:43], v[32:35], v[80:95]
    s_add_u32 m0, s52, 0
    s_add_u32 s48, s37, 0
    buffer_load_dwordx4 v10, s[16:19], s48 offen lds
    v_mfma_f32_32x32x16_bf16 v[96:111], v[44:47], v[32:35], v[96:111]
    s_add_u32 m0, s52, 1024
    s_add_u32 s48, s37, 10240
    buffer_load_dwordx4 v11, s[16:19], s48 offen lds
    s_waitcnt lgkmcnt(0)
    v_mfma_f32_32x32x16_bf16 v[64:79], v[20:23], v[16:19], v[64:79]
    ds_read_b128 v[32:35], v5
    ds_read_b64_tr_b16 v[36:37], v8 offset:3072
    ds_read_b64_tr_b16 v[38:39], v8 offset:3840
    ds_read_b64_tr_b16 v[40:41], v8 offset:3136
    ds_read_b64_tr_b16 v[42:43], v8 offset:3904
    ds_read_b64_tr_b16 v[44:45], v8 offset:3200
    ds_read_b64_tr_b16 v[46:47], v8 offset:3968
    v_mfma_f32_32x32x16_bf16 v[80:95], v[24:27], v[16:19], v[80:95]
    s_add_u32 m0, s53, 0
    s_nop 0
    buffer_load_dwordx4 v12, s[20:23], s38 offen lds
    v_mfma_f32_32x32x16_bf16 v[96:111], v[28:31], v[16:19], v[96:111]
    s_waitcnt lgkmcnt(0)
    v_mfma_f32_32x32x16_bf16 v[64:79], v[36:39], v[32:35], v[64:79]
    ds_read_b128 v[16:19], v6
    ds_read_b64_tr_b16 v[20:21], v8 offset:6144
    ds_read_b64_tr_b16 v[22:23], v8 offset:6912
    ds_read_b64_tr_b16 v[24:25], v8 offset:6208
    ds_read_b64_tr_b16 v[26:27], v8 offset:6976
    ds_read_b64_tr_b16 v[28:29], v8 offset:6272
    ds_read_b64_tr_b16 v[30:31], v8 offset:7040
    v_mfma_f32_32x32x16_bf16 v[80:95], v[40:43], v[32:35], v[80:95]
    s_add_u32 m0, s53, 1024
    s_nop 0
    buffer_load_dwordx4 v62, s[20:23], s38 offen lds
    v_mfma_f32_32x32x16_bf16 v[96:111], v[44:47], v[32:35], v[96:111]
    s_waitcnt lgkmcnt(0)
    v_mfma_f32_32x32x16_bf16 v[64:79], v[20:23], v[16:19], v[64:79]
    ds_read_b128 v[32:35], v7
    ds_read_b64_tr_b16 v[36:37], v8 offset:9216
    ds_read_b64_tr_b16 v[38:39], v8 offset:9984
    ds_read_b64_tr_b16 v[40:41], v8 offset:9280
    ds_read_b64_tr_b16 v[42:43], v8 offset:10048
    ds_read_b64_tr_b16 v[44:45], v8 offset:9344
    ds_read_b64_tr_b16 v[46:47], v8 offset:10112
    v_mfma_f32_32x32x16_bf16 v[80:95], v[24:27], v[16:19], v[80:95]
    s_add_u32 m0, s53, 2048
    s_nop 0
    buffer_load_dwordx4 v63, s[20:23], s38 offen lds
    s_add_u32 s56, s56, 1
    s_add_u32 s57, s56, s78
    s_sub_u32 s57, s57, 2
    s_and_b32 s57, s57, 7
    s_add_u32 s57, s57, 2
    s_cmp_lt_u32 s56, 2
    s_cselect_b32 s79, s56, s57
    s_lshl_b32 s57, s79, 7
    s_add_u32 s37, s58, s57
    s_mul_i32 s57, s79, 196608
    s_add_u32 s38, s59, s57
    s_mov_b32 s51, s50
    s_add_u32 s50, s50, 45056
    s_cmp_ge_u32 s50, 135168
    s_cselect_b32 s50, 0, s50
    s_add_u32 s52, s51, s42
    s_add_u32 s53, s51, s43
    s_add_u32 s40, s40, 1
    s_cmp_lt_u32 s40, 7
    s_cbranch_scc1 Lk1R_loop
    v_mfma_f32_32x32x16_bf16 v[96:111], v[28:31], v[16:19], v[96:111]
    s_waitcnt vmcnt(5) lgkmcnt(0)
    s_barrier
    v_mfma_f32_32x32x16_bf16 v[64:79], v[36:39], v[32:35], v[64:79]
    v_add_u32 v4, s50, v56
    v_add_u32 v5, s50, v57
    v_add_u32 v6, s50, v58
    v_add_u32 v7, s50, v59
    v_add_u32 v8, s50, v60
    ds_read_b128 v[16:19], v4
    ds_read_b64_tr_b16 v[20:21], v8 offset:0
    ds_read_b64_tr_b16 v[22:23], v8 offset:768
    ds_read_b64_tr_b16 v[24:25], v8 offset:64
    ds_read_b64_tr_b16 v[26:27], v8 offset:832
    ds_read_b64_tr_b16 v[28:29], v8 offset:128
    ds_read_b64_tr_b16 v[30:31], v8 offset:896
    v_mfma_f32_32x32x16_bf16 v[80:95], v[40:43], v[32:35], v[80:95]
    v_mfma_f32_32x32x16_bf16 v[96:111], v[44:47], v[32:35], v[96:111]
    s_waitcnt lgkmcnt(0)
    v_mfma_f32_32x32x16_bf16 v[64:79], v[20:23], v[16:19], v[64:79]
    ds_read_b128 v[32:35], v5
    ds_read_b64_tr_b16 v[36:37], v8 offset:3072
    ds_read_b64_tr_b16 v[38:39], v8 offset:3840
    ds_read_b64_tr_b16 v[40:41], v8 offset:3136
    ds_read_b64_tr_b16 v[42:43], v8 offset:3904
    ds_read_b64_tr_b16 v[44:45], v8 offset:3200
    ds_read_b64_tr_b16 v[46:47], v8 offset:3968
    v_mfma_f32_32x32x16_bf16 v[80:95], v[24:27], v[16:19], v[80:95]
    v_mfma_f32_32x32x16_bf16 v[96:111], v[28:31], v[16:19], v[96:111]
    s_waitcnt lgkmcnt(0)
    v_mfma_f32_32x32x16_bf16 v[64:79], v[36:39], v[32:35], v[64:79]
    ds_read_b128 v[16:19], v6
    ds_read_b64_tr_b16 v[20:21], v8 offset:6144
    ds_read_b64_tr_b16 v[22:23], v8 offset:6912
    ds_read_b64_tr_b16 v[24:25], v8 offset:6208
    ds_read_b64_tr_b16 v[26:27], v8 offset:6976
    ds_read_b64_tr_b16 v[28:29], v8 offset:6272
    ds_read_b64_tr_b16 v[30:31], v8 offset:7040
    v_mfma_f32_32x32x16_bf16 v[80:95], v[40:43], v[32:35], v[80:95]
    v_mfma_f32_32x32x16_bf16 v[96:111], v[44:47], v[32:35], v[96:111]
    s_waitcnt lgkmcnt(0)
    v_mfma_f32_32x32x16_bf16 v[64:79], v[20:23], v[16:19], v[64:79]
    ds_read_b128 v[32:35], v7
    ds_read_b64_tr_b16 v[36:37], v8 offset:9216
    ds_read_b64_tr_b16 v[38:39], v8 offset:9984
    ds_read_b64_tr_b16 v[40:41], v8 offset:9280
    ds_read_b64_tr_b16 v[42:43], v8 offset:10048
    ds_read_b64_tr_b16 v[44:45], v8 offset:9344
    ds_read_b64_tr_b16 v[46:47], v8 offset:10112
    v_mfma_f32_32x32x16_bf16 v[80:95], v[24:27], v[16:19], v[80:95]
    s_mov_b32 s51, s50
    s_add_u32 s50, s50, 45056
    s_cmp_ge_u32 s50, 135168
    s_cselect_b32 s50, 0, s50
    s_add_u32 s52, s51, s42
    s_add_u32 s53, s51, s43
    v_mfma_f32_32x32x16_bf16 v[96:111], v[28:31], v[16:19], v[96:111]
    s_waitcnt vmcnt(0) lgkmcnt(0)
    s_barrier
    v_mfma_f32_32x32x16_bf16 v[64:79], v[36:39], v[32:35], v[64:79]
    v_add_u32 v4, s50, v56
    v_add_u32 v5, s50, v57
    v_add_u32 v6, s50, v58
    v_add_u32 v7, s50, v59
    v_add_u32 v8, s50, v60
    ds_read_b128 v[16:19], v4
    ds_read_b64_tr_b16 v[20:21], v8 offset:0
    ds_read_b64_tr_b16 v[22:23], v8 offset:768
    ds_read_b64_tr_b16 v[24:25], v8 offset:64
    ds_read_b64_tr_b16 v[26:27], v8 offset:832
    ds_read_b64_tr_b16 v[28:29], v8 offset:128
    ds_read_b64_tr_b16 v[30:31], v8 offset:896
    v_mfma_f32_32x32x16_bf16 v[80:95], v[40:43], v[32:35], v[80:95]
    v_mfma_f32_32x32x16_bf16 v[96:111], v[44:47], v[32:35], v[96:111]
    s_waitcnt lgkmcnt(0)
    v_mfma_f32_32x32x16_bf16 v[64:79], v[20:23], v[16:19], v[64:79]
    ds_read_b128 v[32:35], v5
    ds_read_b64_tr_b16 v[36:37], v8 offset:3072
    ds_read_b64_tr_b16 v[38:39], v8 offset:3840
    ds_read_b64_tr_b16 v[40:41], v8 offset:3136
    ds_read_b64_tr_b16 v[42:43], v8 offset:3904
    ds_read_b64_tr_b16 v[44:45], v8 offset:3200
    ds_read_b64_tr_b16 v[46:47], v8 offset:3968
    v_mfma_f32_32x32x16_bf16 v[80:95], v[24:27], v[16:19], v[80:95]
    v_mfma_f32_32x32x16_bf16 v[96:111], v[28:31], v[16:19], v[96:111]
    s_waitcnt lgkmcnt(0)
    v_mfma_f32_32x32x16_bf16 v[64:79], v[36:39], v[32:35], v[64:79]
    ds_read_b128 v[16:19], v6
    ds_read_b64_tr_b16 v[20:21], v8 offset:6144
    ds_read_b64_tr_b16 v[22:23], v8 offset:6912
    ds_read_b64_tr_b16 v[24:25], v8 offset:6208
    ds_read_b64_tr_b16 v[26:27], v8 offset:6976
    ds_read_b64_tr_b16 v[28:29], v8 offset:6272
    ds_read_b64_tr_b16 v[30:31], v8 offset:7040
    v_mfma_f32_32x32x16_bf16 v[80:95], v[40:43], v[32:35], v[80:95]
    v_mfma_f32_32x32x16_bf16 v[96:111], v[44:47], v[32:35], v[96:111]
    s_waitcnt lgkmcnt(0)
    v_mfma_f32_32x32x16_bf16 v[64:79], v[20:23], v[16:19], v[64:79]
    ds_read_b128 v[32:35], v7
    ds_read_b64_tr_b16 v[36:37], v8 offset:9216
    ds_read_b64_tr_b16 v[38:39], v8 offset:9984
    ds_read_b64_tr_b16 v[40:41], v8 offset:9280
    ds_read_b64_tr_b16 v[42:43], v8 offset:10048
    ds_read_b64_tr_b16 v[44:45], v8 offset:9344
    ds_read_b64_tr_b16 v[46:47], v8 offset:10112
    v_mfma_f32_32x32x16_bf16 v[80:95], v[24:27], v[16:19], v[80:95]
    s_mov_b32 s51, s50
    s_add_u32 s50, s50, 45056
    s_cmp_ge_u32 s50, 135168
    s_cselect_b32 s50, 0, s50
    s_add_u32 s52, s51, s42
    s_add_u32 s53, s51, s43
    v_mfma_f32_32x32x16_bf16 v[96:111], v[28:31], v[16:19], v[96:111]
    s_waitcnt vmcnt(0) lgkmcnt(0)
    s_barrier
    v_mfma_f32_32x32x16_bf16 v[64:79], v[36:39], v[32:35], v[64:79]
    v_mfma_f32_32x32x16_bf16 v[80:95], v[40:43], v[32:35], v[80:95]
    v_mfma_f32_32x32x16_bf16 v[96:111], v[44:47], v[32:35], v[96:111]
    s_nop 15
    s_lshl_b32 s44, s34, 2
    s_add_u32 s44, s44, s47
    s_mul_i32 s45, s44, 98304
    s_mul_i32 s41, s35, 3072
    s_add_u32 s45, s45, s41
    s_add_u32 s45, s45, 8388608
    v_bfe_u32 v13, v2, 4, 1
    v_mul_u32_u24 v13, 49152, v13
    v_lshrrev_b32 v14, 5, v2
    v_lshl_add_u32 v13, v14, 8, v13
    v_and_b32 v14, 15, v2
    v_lshl_add_u32 v13, v14, 4, v13
    s_mov_b32 s54, 0x3fb8aa3b
    s_mov_b32 s55, s54
    v_mov_b32 v2, 2.0
    v_mov_b32 v3, 2.0
    v_pk_mul_f32 v[16:17], v[64:65], s[54:55]
    v_pk_mul_f32 v[18:19], v[66:67], s[54:55]
    v_pk_mul_f32 v[20:21], v[68:69], s[54:55]
    v_pk_mul_f32 v[22:23], v[70:71], s[54:55]
    v_exp_f32 v16, v16
    v_exp_f32 v17, v17
    v_exp_f32 v18, v18
    v_exp_f32 v19, v19
    v_exp_f32 v20, v20
    v_exp_f32 v21, v21
    v_exp_f32 v22, v22
    v_exp_f32 v23, v23
    v_pk_add_f32 v[24:25], v[16:17], v[2:3]
    v_pk_add_f32 v[26:27], v[18:19], v[2:3]
    v_pk_add_f32 v[28:29], v[20:21], v[2:3]
    v_pk_add_f32 v[30:31], v[22:23], v[2:3]
    v_pk_fma_f32 v[16:17], v[16:17], v[24:25], v[2:3]
    v_pk_fma_f32 v[18:19], v[18:19], v[26:27], v[2:3]
    v_pk_fma_f32 v[20:21], v[20:21], v[28:29], v[2:3]
    v_pk_fma_f32 v[22:23], v[22:23], v[30:31], v[2:3]
    v_rcp_f32 v16, v16
    v_rcp_f32 v17, v17
    v_rcp_f32 v18, v18
    v_rcp_f32 v19, v19
    v_rcp_f32 v20, v20
    v_rcp_f32 v21, v21
    v_rcp_f32 v22, v22
    v_rcp_f32 v23, v23
    s_nop 0
    v_pk_fma_f32 v[16:17], v[16:17], -2.0, 1.0 op_sel_hi:[1,0,0]
    v_pk_fma_f32 v[18:19], v[18:19], -2.0, 1.0 op_sel_hi:[1,0,0]
    v_pk_fma_f32 v[20:21], v[20:21], -2.0, 1.0 op_sel_hi:[1,0,0]
    v_pk_fma_f32 v[22:23], v[22:23], -2.0, 1.0 op_sel_hi:[1,0,0]
    v_pk_mul_f32 v[64:65], v[64:65], v[16:17]
    v_pk_mul_f32 v[66:67], v[66:67], v[18:19]
    v_pk_mul_f32 v[68:69], v[68:69], v[20:21]
    v_pk_mul_f32 v[70:71], v[70:71], v[22:23]
    v_cvt_pk_bf16_f32 v32, v64, v65
    v_cvt_pk_bf16_f32 v33, v66, v67
    v_cvt_pk_bf16_f32 v34, v68, v69
    v_cvt_pk_bf16_f32 v35, v70, v71
    v_pk_mul_f32 v[16:17], v[72:73], s[54:55]
    v_pk_mul_f32 v[18:19], v[74:75], s[54:55]
    v_pk_mul_f32 v[20:21], v[76:77], s[54:55]
    v_pk_mul_f32 v[22:23], v[78:79], s[54:55]
    v_exp_f32 v16, v16
    v_exp_f32 v17, v17
    v_exp_f32 v18, v18
    v_exp_f32 v19, v19
    v_exp_f32 v20, v20
    v_exp_f32 v21, v21
    v_exp_f32 v22, v22
    v_exp_f32 v23, v23
    v_pk_add_f32 v[24:25], v[16:17], v[2:3]
    v_pk_add_f32 v[26:27], v[18:19], v[2:3]
    v_pk_add_f32 v[28:29], v[20:21], v[2:3]
    v_pk_add_f32 v[30:31], v[22:23], v[2:3]
    v_pk_fma_f32 v[16:17], v[16:17], v[24:25], v[2:3]
    v_pk_fma_f32 v[18:19], v[18:19], v[26:27], v[2:3]
    v_pk_fma_f32 v[20:21], v[20:21], v[28:29], v[2:3]
    v_pk_fma_f32 v[22:23], v[22:23], v[30:31], v[2:3]
    v_rcp_f32 v16, v16
    v_rcp_f32 v17, v17
    v_rcp_f32 v18, v18
    v_rcp_f32 v19, v19
    v_rcp_f32 v20, v20
    v_rcp_f32 v21, v21
    v_rcp_f32 v22, v22
    v_rcp_f32 v23, v23
    s_nop 0
    v_pk_fma_f32 v[16:17], v[16:17], -2.0, 1.0 op_sel_hi:[1,0,0]
    v_pk_fma_f32 v[18:19], v[18:19], -2.0, 1.0 op_sel_hi:[1,0,0]
    v_pk_fma_f32 v[20:21], v[20:21], -2.0, 1.0 op_sel_hi:[1,0,0]
    v_pk_fma_f32 v[22:23], v[22:23], -2.0, 1.0 op_sel_hi:[1,0,0]
    v_pk_mul_f32 v[72:73], v[72:73], v[16:17]
    v_pk_mul_f32 v[74:75], v[74:75], v[18:19]
    v_pk_mul_f32 v[76:77], v[76:77], v[20:21]
    v_pk_mul_f32 v[78:79], v[78:79], v[22:23]
    v_cvt_pk_bf16_f32 v36, v72, v73
    v_cvt_pk_bf16_f32 v37, v74, v75
    v_cvt_pk_bf16_f32 v38, v76, v77
    v_cvt_pk_bf16_f32 v39, v78, v79
    v_pk_mul_f32 v[16:17], v[80:81], s[54:55]
    v_pk_mul_f32 v[18:19], v[82:83], s[54:55]
    v_pk_mul_f32 v[20:21], v[84:85], s[54:55]
    v_pk_mul_f32 v[22:23], v[86:87], s[54:55]
    v_exp_f32 v16, v16
    v_exp_f32 v17, v17
    v_exp_f32 v18, v18
    v_exp_f32 v19, v19
    v_exp_f32 v20, v20
    v_exp_f32 v21, v21
    v_exp_f32 v22, v22
    v_exp_f32 v23, v23
    v_pk_add_f32 v[24:25], v[16:17], v[2:3]
    v_pk_add_f32 v[26:27], v[18:19], v[2:3]
    v_pk_add_f32 v[28:29], v[20:21], v[2:3]
    v_pk_add_f32 v[30:31], v[22:23], v[2:3]
    v_pk_fma_f32 v[16:17], v[16:17], v[24:25], v[2:3]
    v_pk_fma_f32 v[18:19], v[18:19], v[26:27], v[2:3]
    v_pk_fma_f32 v[20:21], v[20:21], v[28:29], v[2:3]
    v_pk_fma_f32 v[22:23], v[22:23], v[30:31], v[2:3]
    v_rcp_f32 v16, v16
    v_rcp_f32 v17, v17
    v_rcp_f32 v18, v18
    v_rcp_f32 v19, v19
    v_rcp_f32 v20, v20
    v_rcp_f32 v21, v21
    v_rcp_f32 v22, v22
    v_rcp_f32 v23, v23
    s_nop 0
    v_pk_fma_f32 v[16:17], v[16:17], -2.0, 1.0 op_sel_hi:[1,0,0]
    v_pk_fma_f32 v[18:19], v[18:19], -2.0, 1.0 op_sel_hi:[1,0,0]
    v_pk_fma_f32 v[20:21], v[20:21], -2.0, 1.0 op_sel_hi:[1,0,0]
    v_pk_fma_f32 v[22:23], v[22:23], -2.0, 1.0 op_sel_hi:[1,0,0]
    v_pk_mul_f32 v[80:81], v[80:81], v[16:17]
    v_pk_mul_f32 v[82:83], v[82:83], v[18:19]
    v_pk_mul_f32 v[84:85], v[84:85], v[20:21]
    v_pk_mul_f32 v[86:87], v[86:87], v[22:23]
    v_cvt_pk_bf16_f32 v40, v80, v81
    v_cvt_pk_bf16_f32 v41, v82, v83
    v_cvt_pk_bf16_f32 v42, v84, v85
    v_cvt_pk_bf16_f32 v43, v86, v87
    v_pk_mul_f32 v[16:17], v[88:89], s[54:55]
    v_pk_mul_f32 v[18:19], v[90:91], s[54:55]
    v_pk_mul_f32 v[20:21], v[92:93], s[54:55]
    v_pk_mul_f32 v[22:23], v[94:95], s[54:55]
    v_exp_f32 v16, v16
    v_exp_f32 v17, v17
    v_exp_f32 v18, v18
    v_exp_f32 v19, v19
    v_exp_f32 v20, v20
    v_exp_f32 v21, v21
    v_exp_f32 v22, v22
    v_exp_f32 v23, v23
    v_pk_add_f32 v[24:25], v[16:17], v[2:3]
    v_pk_add_f32 v[26:27], v[18:19], v[2:3]
    v_pk_add_f32 v[28:29], v[20:21], v[2:3]
    v_pk_add_f32 v[30:31], v[22:23], v[2:3]
    v_pk_fma_f32 v[16:17], v[16:17], v[24:25], v[2:3]
    v_pk_fma_f32 v[18:19], v[18:19], v[26:27], v[2:3]
    v_pk_fma_f32 v[20:21], v[20:21], v[28:29], v[2:3]
    v_pk_fma_f32 v[22:23], v[22:23], v[30:31], v[2:3]
    v_rcp_f32 v16, v16
    v_rcp_f32 v17, v17
    v_rcp_f32 v18, v18
    v_rcp_f32 v19, v19
    v_rcp_f32 v20, v20
    v_rcp_f32 v21, v21
    v_rcp_f32 v22, v22
    v_rcp_f32 v23, v23
    s_nop 0
    v_pk_fma_f32 v[16:17], v[16:17], -2.0, 1.0 op_sel_hi:[1,0,0]
    v_pk_fma_f32 v[18:19], v[18:19], -2.0, 1.0 op_sel_hi:[1,0,0]
    v_pk_fma_f32 v[20:21], v[20:21], -2.0, 1.0 op_sel_hi:[1,0,0]
    v_pk_fma_f32 v[22:23], v[22:23], -2.0, 1.0 op_sel_hi:[1,0,0]
    v_pk_mul_f32 v[88:89], v[88:89], v[16:17]
    v_pk_mul_f32 v[90:91], v[90:91], v[18:19]
    v_pk_mul_f32 v[92:93], v[92:93], v[20:21]
    v_pk_mul_f32 v[94:95], v[94:95], v[22:23]
    v_cvt_pk_bf16_f32 v44, v88, v89
    v_cvt_pk_bf16_f32 v45, v90, v91
    v_cvt_pk_bf16_f32 v46, v92, v93
    v_cvt_pk_bf16_f32 v47, v94, v95
    v_pk_mul_f32 v[16:17], v[96:97], s[54:55]
    v_pk_mul_f32 v[18:19], v[98:99], s[54:55]
    v_pk_mul_f32 v[20:21], v[100:101], s[54:55]
    v_pk_mul_f32 v[22:23], v[102:103], s[54:55]
    v_exp_f32 v16, v16
    v_exp_f32 v17, v17
    v_exp_f32 v18, v18
    v_exp_f32 v19, v19
    v_exp_f32 v20, v20
    v_exp_f32 v21, v21
    v_exp_f32 v22, v22
    v_exp_f32 v23, v23
    v_pk_add_f32 v[24:25], v[16:17], v[2:3]
    v_pk_add_f32 v[26:27], v[18:19], v[2:3]
    v_pk_add_f32 v[28:29], v[20:21], v[2:3]
    v_pk_add_f32 v[30:31], v[22:23], v[2:3]
    v_pk_fma_f32 v[16:17], v[16:17], v[24:25], v[2:3]
    v_pk_fma_f32 v[18:19], v[18:19], v[26:27], v[2:3]
    v_pk_fma_f32 v[20:21], v[20:21], v[28:29], v[2:3]
    v_pk_fma_f32 v[22:23], v[22:23], v[30:31], v[2:3]
    v_rcp_f32 v16, v16
    v_rcp_f32 v17, v17
    v_rcp_f32 v18, v18
    v_rcp_f32 v19, v19
    v_rcp_f32 v20, v20
    v_rcp_f32 v21, v21
    v_rcp_f32 v22, v22
    v_rcp_f32 v23, v23
    s_nop 0
    v_pk_fma_f32 v[16:17], v[16:17], -2.0, 1.0 op_sel_hi:[1,0,0]
    v_pk_fma_f32 v[18:19], v[18:19], -2.0, 1.0 op_sel_hi:[1,0,0]
    v_pk_fma_f32 v[20:21], v[20:21], -2.0, 1.0 op_sel_hi:[1,0,0]
    v_pk_fma_f32 v[22:23], v[22:23], -2.0, 1.0 op_sel_hi:[1,0,0]
    v_pk_mul_f32 v[96:97], v[96:97], v[16:17]
    v_pk_mul_f32 v[98:99], v[98:99], v[18:19]
    v_pk_mul_f32 v[100:101], v[100:101], v[20:21]
    v_pk_mul_f32 v[102:103], v[102:103], v[22:23]
    v_cvt_pk_bf16_f32 v48, v96, v97
    v_cvt_pk_bf16_f32 v49, v98, v99
    v_cvt_pk_bf16_f32 v50, v100, v101
    v_cvt_pk_bf16_f32 v51, v102, v103
    v_pk_mul_f32 v[16:17], v[104:105], s[54:55]
    v_pk_mul_f32 v[18:19], v[106:107], s[54:55]
    v_pk_mul_f32 v[20:21], v[108:109], s[54:55]
    v_pk_mul_f32 v[22:23], v[110:111], s[54:55]
    v_exp_f32 v16, v16
    v_exp_f32 v17, v17
    v_exp_f32 v18, v18
    v_exp_f32 v19, v19
    v_exp_f32 v20, v20
    v_exp_f32 v21, v21
    v_exp_f32 v22, v22
    v_exp_f32 v23, v23
    v_pk_add_f32 v[24:25], v[16:17], v[2:3]
    v_pk_add_f32 v[26:27], v[18:19], v[2:3]
    v_pk_add_f32 v[28:29], v[20:21], v[2:3]
    v_pk_add_f32 v[30:31], v[22:23], v[2:3]
    v_pk_fma_f32 v[16:17], v[16:17], v[24:25], v[2:3]
    v_pk_fma_f32 v[18:19], v[18:19], v[26:27], v[2:3]
    v_pk_fma_f32 v[20:21], v[20:21], v[28:29], v[2:3]
    v_pk_fma_f32 v[22:23], v[22:23], v[30:31], v[2:3]
    v_rcp_f32 v16, v16
    v_rcp_f32 v17, v17
    v_rcp_f32 v18, v18
    v_rcp_f32 v19, v19
    v_rcp_f32 v20, v20
    v_rcp_f32 v21, v21
    v_rcp_f32 v22, v22
    v_rcp_f32 v23, v23
    s_nop 0
    v_pk_fma_f32 v[16:17], v[16:17], -2.0, 1.0 op_sel_hi:[1,0,0]
    v_pk_fma_f32 v[18:19], v[18:19], -2.0, 1.0 op_sel_hi:[1,0,0]
    v_pk_fma_f32 v[20:21], v[20:21], -2.0, 1.0 op_sel_hi:[1,0,0]
    v_pk_fma_f32 v[22:23], v[22:23], -2.0, 1.0 op_sel_hi:[1,0,0]
    v_pk_mul_f32 v[104:105], v[104:105], v[16:17]
    v_pk_mul_f32 v[106:107], v[106:107], v[18:19]
    v_pk_mul_f32 v[108:109], v[108:109], v[20:21]
    v_pk_mul_f32 v[110:111], v[110:111], v[22:23]
    v_cvt_pk_bf16_f32 v52, v104, v105
    v_cvt_pk_bf16_f32 v53, v106, v107
    v_cvt_pk_bf16_f32 v54, v108, v109
    v_cvt_pk_bf16_f32 v55, v110, v111
    v_mbcnt_lo_u32_b32 v16, -1, 0
    v_mbcnt_hi_u32_b32 v16, -1, v16
    v_and_b32 v16, 7, v16
    v_lshlrev_b32 v16, 2, v16
    v_add_u32 v16, 155648, v16
    s_mov_b32 s99, 0x100000
Llsp_9:
    ds_read_b32 v17, v16
    s_waitcnt lgkmcnt(0)
    v_cmp_le_u32 vcc, 1, v17
    s_nop 1
    s_cmp_eq_u64 vcc, exec
    s_cbranch_scc1 Llsp_9_ok
    s_sleep 4
    s_sub_u32 s99, s99, 1
    s_cbranch_scc0 Llsp_9
Llsp_9_ok:
    buffer_store_dwordx4 v[32:35], v13, s[24:27], s45 offen offset:0 sc1
    buffer_store_dwordx4 v[36:39], v13, s[24:27], s45 offen offset:512 sc1
    buffer_store_dwordx4 v[40:43], v13, s[24:27], s45 offen offset:1024 sc1
    buffer_store_dwordx4 v[44:47], v13, s[24:27], s45 offen offset:1536 sc1
    buffer_store_dwordx4 v[48:51], v13, s[24:27], s45 offen offset:2048 sc1
    buffer_store_dwordx4 v[52:55], v13, s[24:27], s45 offen offset:2560 sc1
    s_branch Lk1_endR
Lk1_H:
    s_cmp_eq_u32 s32, 8
    s_cbranch_scc1 Lk1_H0
    s_sub_u32 s40, s32, 10
    s_cmp_eq_u32 s32, 9
    s_cselect_b32 s40, 2, s40
    s_cmp_eq_u32 s32, 11
    s_cbranch_scc0 Lk1_nocpf
    s_getpc_b64 s[50:51]
Lk1_pc:
    s_sub_u32 s50, s50, Lk1_pc - gated_mix__softmax_full_mha__dense_activation_mish__prompt_kernel
    s_subb_u32 s51, s51, 0
    s_lshr_b32 s52, s2, 3
    s_mul_i32 s52, s52, (Lcode_end - gated_mix__softmax_full_mha__dense_activation_mish__prompt_kernel + 4095) / 4096
    v_add_u32 v20, s52, v2
    v_min_u32 v20, (Lcode_end - gated_mix__softmax_full_mha__dense_activation_mish__prompt_kernel - 4) / 128, v20
    v_lshlrev_b32 v20, 7, v20
    v_cmp_gt_u32 vcc, (Lcode_end - gated_mix__softmax_full_mha__dense_activation_mish__prompt_kernel + 4095) / 4096, v2
    s_and_saveexec_b64 s[52:53], vcc
    global_load_dword v21, v20, s[50:51]
    s_mov_b64 exec, s[52:53]
Lk1_nocpf:
    s_cmp_eq_u32 s32, 10
    s_cbranch_scc0 Lk1_Hn2
    v_lshlrev_b32 v3, 2, v2
    v_add_u32 v3, 155648, v3
    v_mov_b32 v4, 0
    ds_write_b32 v3, v4
    s_waitcnt lgkmcnt(0)
Lk1_Hn2:
    s_cmp_eq_u32 s32, 9
    s_cbranch_scc0 Lk1_Hn1
    s_load_dwordx2 s[50:51], s[0:1], 72
    s_waitcnt lgkmcnt(0)
    s_mov_b32 s52, s50
    s_and_b32 s53, s51, 0xffff
    s_mov_b32 s54, 256
    s_mov_b32 s55, 0x00020000
    s_cmp_eq_u32 s2, 0
    s_cbranch_scc0 Lk1_Hn1
    s_memrealtime s[50:51]
    s_waitcnt lgkmcnt(0)
    s_or_b32 s50, s50, 1
    v_mov_b32 v3, s50
    v_mov_b32 v4, 0
    s_mov_b64 exec, 1
    buffer_store_dword v3, v4, s[52:55], 0 offen sc1
    s_mov_b64 exec, -1
Lk1_Hn1:
    s_lshl_b32 s41, s40, 8
    s_add_u32 s41, s41, s2
    s_mul_i32 s45, s41, 6554
    s_lshr_b32 s45, s45, 16
    s_mul_i32 s47, s45, 10
    s_sub_u32 s47, s41, s47
    s_cmp_lt_u32 s45, 48
    s_cselect_b32 s96, s80, s82
    s_cselect_b32 s97, s81, s83
    s_mov_b32 s98, 1966080
    s_cselect_b32 s98, s98, 819200
    s_cselect_b32 s100, 0, 48
    s_and_b32 s97, s97, 0xffff
    s_mov_b32 s99, 0x00020000
    s_sub_u32 s100, s45, s100
    s_mul_i32 s100, s100, 40960
    s_lshl_b32 s101, s47, 7
    s_add_u32 s100, s100, s101
    s_lshl_b32 s77, s47, 2
    s_mul_i32 s101, s45, 5120
    s_lshl_b32 s75, s40, 12
    s_add_u32 s75, s75, 136704
    s_cmp_lt_u32 s41, 680
    s_cselect_b32 s76, 1, 0
    v_lshrrev_b32 v8, 3, v2
    v_mul_u32_u24 v8, 1280, v8
    v_and_b32 v3, 7, v2
    v_lshl_add_u32 v8, v3, 4, v8
    v_lshrrev_b32 v9, 4, v2
    v_bfe_u32 v3, v2, 2, 2
    v_lshl_add_u32 v9, v9, 3, v3
    v_lshlrev_b32 v9, 7, v9
    v_and_b32 v3, 3, v2
    v_lshl_add_u32 v9, v3, 3, v9
    v_add_u32 v9, s75, v9
    v_lshlrev_b32 v10, 4, v2
    s_barrier
    s_barrier
    s_cmp_eq_u32 s76, 1
    s_cbranch_scc0 Lk1_nous
    s_add_u32 m0, s75, 0
    s_add_u32 s48, s100, 0
    buffer_load_dwordx4 v8, s[96:99], s48 offen lds
    s_add_u32 m0, s75, 1024
    s_add_u32 s48, s100, 10240
    buffer_load_dwordx4 v8, s[96:99], s48 offen lds
    s_add_u32 m0, s75, 2048
    s_add_u32 s48, s100, 20480
    buffer_load_dwordx4 v8, s[96:99], s48 offen lds
    s_add_u32 m0, s75, 3072
    s_add_u32 s48, s100, 30720
    buffer_load_dwordx4 v8, s[96:99], s48 offen lds
Lk1_nous:
    s_barrier
    s_barrier
    s_barrier
    s_cmp_eq_u32 s32, 9
    s_cbranch_scc0 Lk1_notag
    v_mov_b32 v4, 0
    s_mov_b32 s50, 0x40000
Lk1_tagpoll:
    buffer_load_dword v3, v4, s[52:55], 0 offen sc1
    s_waitcnt vmcnt(0)
    v_readfirstlane_b32 s51, v3
    s_nop 3
    s_cmp_lg_u32 s51, 0
    s_cbranch_scc1 Lk1_gottag
    s_sleep 4
    s_sub_u32 s50, s50, 1
    s_cbranch_scc0 Lk1_tagpoll
Lk1_gottag:
    v_mov_b32 v4, 155772
    ds_write_b32 v4, v3
    s_waitcnt lgkmcnt(0)
Lk1_notag:
    s_barrier
    s_barrier
    s_barrier
    s_barrier
    s_cmp_eq_u32 s76, 1
    s_cbranch_scc0 Lk1_nouf
    s_waitcnt vmcnt(0)
    ds_read_b64_tr_b16 v[20:21], v9 offset:0
    ds_read_b64_tr_b16 v[22:23], v9 offset:512
    ds_read_b64_tr_b16 v[24:25], v9 offset:32
    ds_read_b64_tr_b16 v[26:27], v9 offset:544
    ds_read_b64_tr_b16 v[28:29], v9 offset:64
    ds_read_b64_tr_b16 v[30:31], v9 offset:576
    ds_read_b64_tr_b16 v[32:33], v9 offset:96
    ds_read_b64_tr_b16 v[34:35], v9 offset:608
    s_waitcnt lgkmcnt(0)
    s_add_u32 s41, s77, 0
    s_mul_i32 s45, s41, 205
    s_lshr_b32 s45, s45, 10
    s_mul_i32 s47, s45, 5
    s_sub_u32 s47, s41, s47
    s_mul_i32 s45, s45, 348160
    s_lshl_b32 s47, s47, 10
    s_add_u32 s45, s45, s47
    s_add_u32 s45, s45, s101
    s_add_u32 s45, s45, 17825792
    buffer_store_dwordx4 v[20:23], v10, s[24:27], s45 offen sc1
    s_add_u32 s41, s77, 1
    s_mul_i32 s45, s41, 205
    s_lshr_b32 s45, s45, 10
    s_mul_i32 s47, s45, 5
    s_sub_u32 s47, s41, s47
    s_mul_i32 s45, s45, 348160
    s_lshl_b32 s47, s47, 10
    s_add_u32 s45, s45, s47
    s_add_u32 s45, s45, s101
    s_add_u32 s45, s45, 17825792
    buffer_store_dwordx4 v[24:27], v10, s[24:27], s45 offen sc1
    s_add_u32 s41, s77, 2
    s_mul_i32 s45, s41, 205
    s_lshr_b32 s45, s45, 10
    s_mul_i32 s47, s45, 5
    s_sub_u32 s47, s41, s47
    s_mul_i32 s45, s45, 348160
    s_lshl_b32 s47, s47, 10
    s_add_u32 s45, s45, s47
    s_add_u32 s45, s45, s101
    s_add_u32 s45, s45, 17825792
    buffer_store_dwordx4 v[28:31], v10, s[24:27], s45 offen sc1
    s_add_u32 s41, s77, 3
    s_mul_i32 s45, s41, 205
    s_lshr_b32 s45, s45, 10
    s_mul_i32 s47, s45, 5
    s_sub_u32 s47, s41, s47
    s_mul_i32 s45, s45, 348160
    s_lshl_b32 s47, s47, 10
    s_add_u32 s45, s45, s47
    s_add_u32 s45, s45, s101
    s_add_u32 s45, s45, 17825792
    buffer_store_dwordx4 v[32:35], v10, s[24:27], s45 offen sc1
Lk1_nouf:
    s_barrier
    s_barrier
    s_barrier
    s_waitcnt vmcnt(0)
    s_lshl_b32 s41, s40, 2
    s_add_u32 s41, s41, 155776
    v_mov_b32 v4, s41
    v_mov_b32 v5, 1
    ds_write_b32 v4, v5
    s_cmp_eq_u32 s32, 11
    s_cbranch_scc0 Lattn_entry
    v_mbcnt_lo_u32_b32 v2, -1, 0
    v_mbcnt_hi_u32_b32 v2, -1, v2
    v_and_b32 v2, 3, v2
    v_lshlrev_b32 v2, 2, v2
    v_add_u32 v2, 155776, v2
    s_mov_b32 s99, 0x100000
Llsp_10:
    ds_read_b32 v3, v2
    s_waitcnt lgkmcnt(0)
    v_cmp_le_u32 vcc, 1, v3
    s_nop 1
    s_cmp_eq_u64 vcc, exec
    s_cbranch_scc1 Llsp_10_ok
    s_sleep 1
    s_sub_u32 s99, s99, 1
    s_cbranch_scc0 Llsp_10
Llsp_10_ok:
    v_mov_b32 v2, 155772
    s_mov_b32 s99, 0x100000
Ltag_11:
    ds_read_b32 v3, v2
    s_waitcnt lgkmcnt(0)
    v_readfirstlane_b32 s50, v3
    s_nop 3
    s_cmp_lg_u32 s50, 0
    s_cbranch_scc1 Ltag_11_ok
    s_sleep 2
    s_sub_u32 s99, s99, 1
    s_cbranch_scc0 Ltag_11
Ltag_11_ok:
    v_mbcnt_lo_u32_b32 v2, -1, 0
    v_mbcnt_hi_u32_b32 v2, -1, v2
    v_mul_u32_u24 v3, 4352, v2
    v_mov_b32 v4, s50
    s_lshl_b32 s98, s2, 2
    s_add_u32 s98, s98, 24772608
    s_mov_b64 exec, 0xff
    buffer_store_dword v4, v3, s[24:27], s98 offen sc1
    s_mov_b64 exec, -1
    s_branch Lattn_entry
Lk1_H0:
    s_setprio 0
    s_cmp_lt_u32 s35, 10
    s_cbranch_scc1 Lk1_noconst
    s_cmp_eq_u32 s35, 15
    s_cbranch_scc1 Lk1_noconst
    s_lshl_b32 s41, s46, 7
    s_add_u32 s42, s41, 19
    s_mul_i32 s42, s42, 3277
    s_lshr_b32 s42, s42, 16
    s_add_u32 s43, s41, 127
    s_mul_i32 s43, s43, 3277
    s_lshr_b32 s43, s43, 16
    s_min_u32 s43, s43, 31
    v_lshrrev_b32 v11, 5, v2
    v_bfe_u32 v12, v2, 3, 2
    s_lshl_b32 s44, s34, 2
    v_add_u32 v12, s44, v12
    v_lshrrev_b32 v13, 3, v12
    v_mul_u32_u24 v13, 21504, v13
    v_and_b32 v12, 7, v12
    v_mul_u32_u24 v12, 1408, v12
    v_add_u32 v12, v12, v13
    v_bfe_u32 v13, v2, 1, 2
    v_mul_u32_u24 v13, 352, v13
    v_add_u32 v12, v12, v13
    v_and_b32 v13, 1, v2
    v_mul_u32_u24 v14, 112, v13
    v_add_u32 v12, v12, v14
    v_add_u32 v12, 2631808, v12
    v_cmp_eq_u32 vcc, 0, v13
    v_mov_b32 v14, 0x3f803f80
    s_mov_b32 s45, 172032
    v_cndmask_b32 v20, 0, v14, vcc
    v_mov_b32 v21, v20
    v_mov_b32 v22, v20
    v_mov_b32 v23, v20
    s_mov_b32 s88, s42
    s_mov_b32 s89, s43
    s_mov_b32 s90, s45
    s_mov_b32 s91, 1
    s_add_u32 s47, s88, 0
    v_add_u32 v15, s47, v11
    v_cmp_ge_u32 vcc, s89, v15
    v_mul_lo_u32 v15, v15, s90
    v_add_u32 v15, v15, v12
    s_and_saveexec_b64 s[50:51], vcc
    s_cbranch_execz Lcv_12
    buffer_store_dwordx4 v[20:23], v15, s[24:27], 0 offen sc1
Lcv_12:
    s_mov_b64 exec, s[50:51]
    s_add_u32 s47, s88, 2
    v_add_u32 v15, s47, v11
    v_cmp_ge_u32 vcc, s89, v15
    v_mul_lo_u32 v15, v15, s90
    v_add_u32 v15, v15, v12
    s_and_saveexec_b64 s[50:51], vcc
    s_cbranch_execz Lcv_13
    buffer_store_dwordx4 v[20:23], v15, s[24:27], 0 offen sc1
Lcv_13:
    s_mov_b64 exec, s[50:51]
    s_add_u32 s47, s88, 4
    v_add_u32 v15, s47, v11
    v_cmp_ge_u32 vcc, s89, v15
    v_mul_lo_u32 v15, v15, s90
    v_add_u32 v15, v15, v12
    s_and_saveexec_b64 s[50:51], vcc
    s_cbranch_execz Lcv_14
    buffer_store_dwordx4 v[20:23], v15, s[24:27], 0 offen sc1
Lcv_14:
    s_mov_b64 exec, s[50:51]
    s_add_u32 s47, s88, 6
    v_add_u32 v15, s47, v11
    v_cmp_ge_u32 vcc, s89, v15
    v_mul_lo_u32 v15, v15, s90
    v_add_u32 v15, v15, v12
    s_and_saveexec_b64 s[50:51], vcc
    s_cbranch_execz Lcv_15
    buffer_store_dwordx4 v[20:23], v15, s[24:27], 0 offen sc1
Lcv_15:
    s_mov_b64 exec, s[50:51]
    s_branch Lk1_hasconst
Lk1_noconst:
    s_mov_b32 s91, 0
Lk1_hasconst:
    s_and_b32 s41, s2, 7
    s_and_b32 s43, s41, 1
    s_lshr_b32 s44, s41, 1
    s_lshr_b32 s45, s2, 3
    v_mov_b32 v13, 0x7ffffff0
    s_lshl_b32 s46, s43, 10
    s_lshl_b32 s47, s45, 5
    s_add_u32 s46, s46, s47
    v_add_u32 v3, s46, v2
    v_mul_u32_u24 v3, 1280, v3
    v_cmp_gt_u32 vcc, 32, v2
    s_nop 1
    v_cndmask_b32 v4, v13, v3, vcc
    v_lshrrev_b32 v3, 3, v2
    s_lshl_b32 s47, s45, 1
    v_add_u32 v3, s47, v3
    v_mul_u32_u24 v3, 3840, v3
    v_and_b32 v5, 7, v2
    v_lshlrev_b32 v5, 7, v5
    s_lshl_b32 s48, s44, 10
    v_add_u32 v5, s48, v5
    v_cmp_gt_u32 vcc, 3840, v5
    v_add_u32 v5, v5, v3
    v_cmp_gt_u32 s[50:51], 16, v2
    s_and_b64 vcc, vcc, s[50:51]
    s_nop 1
    v_cndmask_b32 v5, v13, v5, vcc
    v_cmp_lt_u32 vcc, 5, v2
    v_mov_b32 v6, 0
    v_mov_b32 v7, 1
    v_cndmask_b32 v3, v6, v7, vcc
    v_mul_u32_u24 v6, 6, v3
    v_sub_u32 v6, v2, v6
    v_lshlrev_b32 v6, 7, v6
    v_add_u32 v3, s47, v3
    v_mul_u32_u24 v3, 3072, v3
    v_add_u32 v6, v6, v3
    s_mul_i32 s48, s44, 768
    v_add_u32 v6, s48, v6
    v_cmp_gt_u32 vcc, 12, v2
    s_nop 1
    v_cndmask_b32 v6, v13, v6, vcc
    s_barrier
    s_barrier
    s_barrier
    s_barrier
    s_barrier
    s_barrier
    s_barrier
    s_barrier
    s_barrier
    s_barrier
    s_barrier
    s_barrier
    s_waitcnt vmcnt(0)
    v_mov_b32 v2, 155788
    v_mov_b32 v3, 1
    ds_write_b32 v2, v3
    s_branch Lattn_entry
Lk1_endR:
    s_waitcnt vmcnt(0)
    s_sub_u32 s41, s32, 4
    s_lshl_b32 s41, s41, 2
    s_add_u32 s41, s41, 155744
    v_mov_b32 v4, s41
    v_mov_b32 v5, 1
    ds_write_b32 v4, v5
    s_branch Lshadow_entry
Lk1_end:
    s_waitcnt vmcnt(0)
    s_lshl_b32 s41, s32, 2
    s_add_u32 s41, s41, 155728
    v_mov_b32 v4, s41
    v_mov_b32 v5, 1
    ds_write_b32 v4, v5
    s_branch Lattn_entry
Lk1_exit:
    s_endpgm
Lshadow_entry:
    s_load_dwordx2 s[4:5], s[0:1], 80
    v_lshrrev_b32 v9, 6, v0
    v_and_b32 v1, 63, v0
    s_and_b32 s20, s2, 7
    v_readfirstlane_b32 s12, v9
    s_lshr_b32 s21, s2, 3
    s_and_b32 s22, s21, 3
    s_lshl_b32 s13, s20, 2
    s_add_u32 s13, s13, s22
    s_lshr_b32 s14, s21, 2
    s_lshl_b32 s15, s14, 3
    s_add_u32 s15, s15, s12
    s_branch Lk2_shadow
Lattn_entry:
    s_setprio 0
    s_load_dwordx2 s[4:5], s[0:1], 80
    v_lshrrev_b32 v9, 6, v0
    v_and_b32 v1, 63, v0
    s_and_b32 s20, s2, 7
    v_readfirstlane_b32 s12, v9
    s_lshr_b32 s21, s2, 3
    s_and_b32 s22, s21, 3
    s_lshl_b32 s13, s20, 2
    s_add_u32 s13, s13, s22
    s_lshr_b32 s14, s21, 2
    s_lshl_b32 s15, s14, 3
    s_add_u32 s15, s15, s12
    s_mul_i32 s16, s13, 172032
    s_add_u32 s16, s16, 2621440
    s_mul_i32 s23, s13, 81920
    s_mul_i32 s24, s15, 1280
    s_add_u32 s23, s23, s24
    s_add_u32 s23, s23, 0
    v_lshlrev_b32 v8, 4, v1
    v_and_b32 v9, 31, v1
    v_lshrrev_b32 v10, 5, v1
    v_lshlrev_b32 v11, 3, v9
    v_add_u32 v11, 1024, v11
    s_mul_i32 s25, s12, 3072
    s_add_u32 s17, s16, s25
    s_waitcnt lgkmcnt(0)
    s_mov_b32 s8, s4
    s_and_b32 s9, s5, 0xffff
    s_mov_b32 s10, 33554432
    s_mov_b32 s11, 0x00020000
    v_cmp_gt_u32 s[28:29], 32, v1
    v_mov_b32 v5, v8
    v_mul_u32_u24 v6, 1280, v10
    v_add_u32 v6, v6, v11
    s_and_b32 s20, s13, 1
    s_mov_b32 s21, 0x43120
    s_cmp_eq_u32 s20, 1
    s_cselect_b32 s21, 0x04231, s21
    v_lshrrev_b32 v14, 2, v9
    v_lshlrev_b32 v14, 2, v14
    v_lshrrev_b32 v15, v14, s21
    v_and_b32 v15, 15, v15
    v_and_b32 v14, 3, v9
    v_lshl_add_u32 v15, v15, 2, v14
    v_cmp_gt_u32 vcc, 20, v9
    s_nop 1
    v_cndmask_b32 v16, v9, v15, vcc
    v_mov_b32 v14, v16
    v_add_u32 v15, 12, v16
    v_cmp_lt_u32 vcc, 3, v16
    s_nop 1
    v_cndmask_b32 v14, v14, v15, vcc
    v_subrev_u32 v15, 1, v16
    v_cmp_lt_u32 vcc, 9, v16
    s_nop 1
    v_cndmask_b32 v14, v14, v15, vcc
    v_subrev_u32 v15, 8, v16
    v_cmp_lt_u32 vcc, 11, v16
    s_nop 1
    v_cndmask_b32 v14, v14, v15, vcc
    v_subrev_u32 v15, 5, v16
    v_cmp_lt_u32 vcc, 15, v16
    s_nop 1
    v_cndmask_b32 v14, v14, v15, vcc
    v_cmp_lt_u32 vcc, 19, v16
    s_nop 1
    v_cndmask_b32 v14, v14, 8, vcc
    v_cmp_lt_u32 vcc, 20, v16
    s_nop 1
    v_cndmask_b32 v14, v14, 15, vcc
    s_mul_i32 s21, s13, 5
    v_and_b32 v16, 15, v1
    v_lshlrev_b32 v16, 4, v16
    v_bfe_u32 v17, v1, 4, 1
    v_mul_u32_u24 v17, 20480, v17
    v_add_u32 v16, v16, v17
    v_lshlrev_b32 v17, 1, v10
    v_add_u32 v17, s20, v17
    v_add_u32 v17, s21, v17
    v_lshrrev_b32 v18, 3, v17
    v_lshlrev_b32 v18, 10, v18
    v_bfe_u32 v17, v17, 1, 2
    v_lshl_add_u32 v18, v17, 8, v18
    v_add_u32 v152, v18, v16
    s_xor_b32 s20, s20, 1
    s_lshl_b32 s20, s20, 2
    s_add_u32 s20, s20, s21
    s_lshr_b32 s21, s20, 3
    s_lshl_b32 s21, s21, 10
    s_bfe_u32 s22, s20, 0x20001
    s_lshl_b32 s22, s22, 8
    s_add_u32 s21, s21, s22
    s_and_b32 s20, s20, 1
    s_lshl_b32 s20, s20, 3
    s_add_u32 s21, s21, s20
    v_add_u32 v153, s21, v16
    v_mul_u32_u24 v7, 352, v10
    v_lshl_add_u32 v7, v14, 4, v7
    v_add_u32 v7, 10240, v7
    v_mov_b32 v2, v5
    v_mov_b32 v3, v6
    v_mov_b32 v4, v7
    v_and_b32 v12, 7, v1
    v_lshlrev_b32 v12, 2, v12
    v_add_u32 v12, 155648, v12
    s_lshl_b32 s33, s12, 2
    s_add_u32 s33, s33, 155648
    v_mov_b32 v13, s33
    v_mov_b32 v140, 0
    v_mov_b32 v141, 0
    v_mov_b32 v142, 0
    v_mov_b32 v143, 0
    v_mov_b32 v84, 0
    v_mov_b32 v85, 0
    v_mov_b32 v86, 0
    v_mov_b32 v87, 0
    v_mov_b32 v88, 0
    v_mov_b32 v89, 0
    v_mov_b32 v90, 0
    v_mov_b32 v91, 0
    v_mov_b32 v92, 0
    v_mov_b32 v93, 0
    v_mov_b32 v94, 0
    v_mov_b32 v95, 0
    v_mov_b32 v96, 0
    v_mov_b32 v97, 0
    v_mov_b32 v98, 0
    v_mov_b32 v99, 0
    v_mov_b32 v100, 0
    v_mov_b32 v101, 0
    v_mov_b32 v102, 0
    v_mov_b32 v103, 0
    s_cmp_eq_u32 s12, 5
    s_cbranch_scc0 Lattn_nopub
    v_mbcnt_lo_u32_b32 v146, -1, 0
    v_mbcnt_hi_u32_b32 v146, -1, v146
    v_and_b32 v146, 0, v146
    v_lshlrev_b32 v146, 2, v146
    v_add_u32 v146, 155788, v146
    s_mov_b32 s99, 0x100000
Llsp_10001:
    ds_read_b32 v147, v146
    s_waitcnt lgkmcnt(0)
    v_cmp_le_u32 vcc, 1, v147
    s_nop 1
    s_cmp_eq_u64 vcc, exec
    s_cbranch_scc1 Llsp_10001_ok
    s_sleep 0
    s_sub_u32 s99, s99, 1
    s_cbranch_scc0 Llsp_10001
Llsp_10001_ok:
    v_mbcnt_lo_u32_b32 v146, -1, 0
    v_mbcnt_hi_u32_b32 v146, -1, v146
    v_and_b32 v146, 3, v146
    v_lshlrev_b32 v146, 2, v146
    v_add_u32 v146, 155728, v146
    s_mov_b32 s99, 0x100000
Llsp_10002:
    ds_read_b32 v147, v146
    s_waitcnt lgkmcnt(0)
    v_cmp_le_u32 vcc, 1, v147
    s_nop 1
    s_cmp_eq_u64 vcc, exec
    s_cbranch_scc1 Llsp_10002_ok
    s_sleep 0
    s_sub_u32 s99, s99, 1
    s_cbranch_scc0 Llsp_10002
Llsp_10002_ok:
    v_mov_b32 v146, 155772
    s_mov_b32 s99, 0x100000
Ltag_10003:
    ds_read_b32 v147, v146
    s_waitcnt lgkmcnt(0)
    v_readfirstlane_b32 s35, v147
    s_nop 3
    s_cmp_lg_u32 s35, 0
    s_cbranch_scc1 Ltag_10003_ok
    s_sleep 2
    s_sub_u32 s99, s99, 1
    s_cbranch_scc0 Ltag_10003
Ltag_10003_ok:
    s_and_b32 s20, s2, 7
    s_lshr_b32 s21, s2, 3
    s_and_b32 s22, s20, 1
    s_lshl_b32 s22, s22, 3
    s_and_b32 s24, s21, 7
    s_add_u32 s22, s22, s24
    s_lshr_b32 s20, s20, 1
    s_lshl_b32 s20, s20, 2
    s_lshr_b32 s21, s21, 3
    s_add_u32 s20, s20, s21
    s_mul_i32 s20, s20, 4352
    s_lshl_b32 s22, s22, 2
    s_add_u32 s20, s20, s22
    s_add_u32 s20, s20, 23068672
    v_mul_u32_u24 v146, 69888, v1
    v_mov_b32 v147, s35
    s_mov_b64 exec, 0xf
    buffer_store_dword v147, v146, s[8:11], s20 offen sc1
    s_mov_b64 exec, -1
Lattn_nopub:
    s_cmp_eq_u32 s12, 4
    s_cbranch_scc0 Lattn_wgo
    v_mov_b32 v146, 155772
    s_mov_b32 s99, 0x100000
Ltag_10004:
    ds_read_b32 v147, v146
    s_waitcnt lgkmcnt(0)
    v_readfirstlane_b32 s35, v147
    s_nop 3
    s_cmp_lg_u32 s35, 0
    s_cbranch_scc1 Ltag_10004_ok
    s_sleep 2
    s_sub_u32 s99, s99, 1
    s_cbranch_scc0 Ltag_10004
Ltag_10004_ok:
    v_mbcnt_lo_u32_b32 v146, -1, 0
    v_mbcnt_hi_u32_b32 v146, -1, v146
    v_and_b32 v146, 3, v146
    v_lshlrev_b32 v146, 2, v146
    v_add_u32 v146, 155728, v146
    s_mov_b32 s99, 0x100000
Llsp_10005:
    ds_read_b32 v147, v146
    s_waitcnt lgkmcnt(0)
    v_cmp_le_u32 vcc, 1, v147
    s_nop 1
    s_cmp_eq_u64 vcc, exec
    s_cbranch_scc1 Llsp_10005_ok
    s_sleep 1
    s_sub_u32 s99, s99, 1
    s_cbranch_scc0 Llsp_10005
Llsp_10005_ok:
    s_sleep 24
    s_mul_i32 s20, s13, 20
    s_add_u32 s21, s20, 19
    s_lshr_b32 s20, s20, 7
    s_lshr_b32 s21, s21, 7
    v_and_b32 v146, 15, v1
    v_lshlrev_b32 v146, 2, v146
    v_bfe_u32 v147, v1, 4, 1
    v_mov_b32 v148, s20
    v_mov_b32 v149, s21
    v_cmp_eq_u32 vcc, 1, v147
    s_nop 1
    v_cndmask_b32 v148, v148, v149, vcc
    v_lshrrev_b32 v147, 5, v1
    v_mul_u32_u24 v147, 5, v147
    v_add_u32 v147, 5, v147
    v_add_u32 v147, v147, v148
    v_mul_u32_u24 v147, 4352, v147
    v_add_u32 v147, v147, v146
    v_mul_u32_u24 v148, 4352, v148
    v_add_u32 v148, v148, v146
    v_bfe_u32 v149, v1, 1, 3
    v_cmp_eq_u32 s[36:37], s14, v149
    v_cmp_gt_u32 vcc, 32, v1
    s_and_b64 s[36:37], s[36:37], vcc
    s_lshr_b32 s20, s2, 3
    s_and_b32 s20, s20, 3
    s_mul_i32 s20, s20, 69888
    s_add_u32 s20, s20, 23068672
    s_mov_b32 s45, s20
    s_mov_b64 s[46:47], -1
    s_mov_b32 s34, 0x40000
Lattn_poll:
    buffer_load_dword v150, v147, s[8:11], s45 offen sc1
    buffer_load_dword v151, v148, s[8:11], s45 offen sc1
    s_waitcnt vmcnt(0)
    v_cmp_eq_u32 vcc, s35, v150
    v_cmp_eq_u32 s[38:39], s35, v151
    s_orn2_b64 vcc, vcc, s[46:47]
    s_orn2_b64 s[38:39], s[38:39], s[36:37]
    s_and_b64 vcc, vcc, s[38:39]
    s_cmp_eq_u64 vcc, exec
    s_cbranch_scc1 Lattn_polled
    s_sleep 8
    s_sub_u32 s34, s34, 1
    s_cbranch_scc0 Lattn_poll
Lattn_polled:
    v_mov_b32 v146, 155764
    v_mov_b32 v149, 1
    ds_write_b32 v146, v149
    s_branch Lattn_go
Lattn_wgo:
    v_mbcnt_lo_u32_b32 v146, -1, 0
    v_mbcnt_hi_u32_b32 v146, -1, v146
    v_and_b32 v146, 0, v146
    v_lshlrev_b32 v146, 2, v146
    v_add_u32 v146, 155764, v146
    s_mov_b32 s99, 0x100000
Llsp_10006:
    ds_read_b32 v147, v146
    s_waitcnt lgkmcnt(0)
    v_cmp_le_u32 vcc, 1, v147
    s_nop 1
    s_cmp_eq_u64 vcc, exec
    s_cbranch_scc1 Llsp_10006_ok
    s_sleep 1
    s_sub_u32 s99, s99, 1
    s_cbranch_scc0 Llsp_10006
Llsp_10006_ok:
Lattn_go:
    s_add_u32 m0, s25, 0
    s_add_u32 s26, s17, 0
    buffer_load_dwordx4 v8, s[8:11], s26 offen lds
    s_add_u32 m0, s25, 1024
    s_add_u32 s26, s17, 1024
    buffer_load_dwordx4 v8, s[8:11], s26 offen lds
    s_add_u32 m0, s25, 2048
    s_add_u32 s26, s17, 2048
    buffer_load_dwordx4 v8, s[8:11], s26 offen lds
    s_add_u32 s17, s17, 21504
    buffer_load_dwordx4 v[120:123], v8, s[8:11], s23 offen
    buffer_load_dwordx2 v[124:125], v11, s[8:11], s23 offen
    s_waitcnt vmcnt(0) lgkmcnt(0)
    s_add_u32 m0, s25, 24576
    s_add_u32 s26, s17, 0
    buffer_load_dwordx4 v8, s[8:11], s26 offen lds
    s_add_u32 m0, s25, 25600
    s_add_u32 s26, s17, 1024
    buffer_load_dwordx4 v8, s[8:11], s26 offen lds
    s_add_u32 m0, s25, 26624
    s_add_u32 s26, s17, 2048
    buffer_load_dwordx4 v8, s[8:11], s26 offen lds
    s_add_u32 s17, s17, 21504
    v_mov_b32 v144, 1
    ds_write_b32 v13, v144
    v_mbcnt_lo_u32_b32 v144, -1, 0
    v_mbcnt_hi_u32_b32 v144, -1, v144
    v_and_b32 v144, 7, v144
    v_lshlrev_b32 v144, 2, v144
    v_add_u32 v144, 155648, v144
    s_mov_b32 s34, 0x100000
Llsp_10007:
    ds_read_b32 v145, v144
    s_waitcnt lgkmcnt(0)
    v_cmp_le_u32 vcc, 1, v145
    s_nop 1
    s_cmp_eq_u64 vcc, exec
    s_cbranch_scc1 Llsp_10007_ok
    s_sleep 0
    s_sub_u32 s34, s34, 1
    s_cbranch_scc0 Llsp_10007
Llsp_10007_ok:
    ds_read_b128 v[126:129], v2
    ds_read_b128 v[130:133], v2 offset:1280
    ds_read_b64 v[134:135], v3
    ds_read_b128 v[136:139], v4
    s_waitcnt lgkmcnt(0)
    v_mfma_f32_32x32x16_bf16 v[16:31], v[126:129], v[120:123], 0
    v_mfma_f32_32x32x16_bf16 v[32:47], v[130:133], v[120:123], 0
    s_nop 11
    v_mfma_f32_32x32x4_2b_bf16 v[16:47], v[134:135], v[124:125], v[16:47]
    s_nop 15
    s_nop 7
    v_max3_f32 v9, v16, v17, v18
    v_max3_f32 v9, v9, v19, v20
    v_max3_f32 v9, v9, v21, v22
    v_max3_f32 v9, v9, v23, v24
    v_max3_f32 v9, v9, v25, v26
    v_max3_f32 v9, v9, v27, v28
    v_max3_f32 v9, v9, v29, v30
    v_max3_f32 v9, v9, v31, v32
    v_max3_f32 v9, v9, v33, v34
    v_max3_f32 v9, v9, v35, v36
    v_max3_f32 v9, v9, v37, v38
    v_max3_f32 v9, v9, v39, v40
    v_max3_f32 v9, v9, v41, v42
    v_max3_f32 v9, v9, v43, v44
    v_max3_f32 v9, v9, v45, v46
    v_max_f32 v9, v9, v47
    v_mov_b32 v10, v9
    s_nop 1
    v_permlane32_swap_b32 v9, v10
    s_nop 1
    v_max_f32 v9, v9, v10
    v_sub_f32 v14, 0, v9
    v_mov_b32 v15, v14
    v_pk_add_f32 v[16:17], v[16:17], v[14:15]
    v_pk_add_f32 v[18:19], v[18:19], v[14:15]
    v_pk_add_f32 v[20:21], v[20:21], v[14:15]
    v_pk_add_f32 v[22:23], v[22:23], v[14:15]
    v_pk_add_f32 v[24:25], v[24:25], v[14:15]
    v_pk_add_f32 v[26:27], v[26:27], v[14:15]
    v_pk_add_f32 v[28:29], v[28:29], v[14:15]
    v_pk_add_f32 v[30:31], v[30:31], v[14:15]
    v_pk_add_f32 v[32:33], v[32:33], v[14:15]
    v_pk_add_f32 v[34:35], v[34:35], v[14:15]
    v_pk_add_f32 v[36:37], v[36:37], v[14:15]
    v_pk_add_f32 v[38:39], v[38:39], v[14:15]
    v_pk_add_f32 v[40:41], v[40:41], v[14:15]
    v_pk_add_f32 v[42:43], v[42:43], v[14:15]
    v_pk_add_f32 v[44:45], v[44:45], v[14:15]
    v_pk_add_f32 v[46:47], v[46:47], v[14:15]
    v_mov_b32 v104, v14
    v_mov_b32 v105, v14
    v_mov_b32 v106, v14
    v_mov_b32 v107, v14
    v_mov_b32 v108, v14
    v_mov_b32 v109, v14
    v_mov_b32 v110, v14
    v_mov_b32 v111, v14
    v_mov_b32 v112, v14
    v_mov_b32 v113, v14
    v_mov_b32 v114, v14
    v_mov_b32 v115, v14
    v_mov_b32 v116, v14
    v_mov_b32 v117, v14
    v_mov_b32 v118, v14
    v_mov_b32 v119, v14
    ds_read_b128 v[126:129], v2 offset:2560
    ds_read_b128 v[130:133], v2 offset:3840
    ds_read_b64 v[134:135], v3 offset:2560
    s_mov_b32 s18, 0
    s_mov_b32 s19, 24576
    s_mov_b32 s27, 49152
    s_setprio 1
    s_cmp_ge_u32 s12, 4
    s_cbranch_scc0 Lk2_noprio
    s_setprio 2
Lk2_noprio:
Lk2_loop:
    s_setprio 3
    s_waitcnt lgkmcnt(0)
    v_mov_b32 v145, s18
    ds_write_b32 v13, v145 offset:32
    v_mfma_f32_32x32x16_bf16 v[48:63], v[126:129], v[120:123], v[104:119]
    ds_read_b128 v[126:129], v2 offset:5120
    v_exp_f32 v16, v16
    v_exp_f32 v17, v17
    v_exp_f32 v18, v18
    v_exp_f32 v19, v19
    v_mfma_f32_32x32x16_bf16 v[88:103], v[140:143], v[84:87], v[88:103]
    ds_read_b128 v[140:143], v4 offset:704
    v_cvt_pk_bf16_f32 v80, v16, v17
    v_exp_f32 v20, v20
    v_cvt_pk_bf16_f32 v81, v18, v19
    v_exp_f32 v21, v21
    v_exp_f32 v22, v22
    v_exp_f32 v23, v23
    v_mfma_f32_32x32x16_bf16 v[64:79], v[130:133], v[120:123], v[104:119]
    ds_read_b128 v[130:133], v2 offset:6400
    v_cvt_pk_bf16_f32 v82, v20, v21
    v_exp_f32 v24, v24
    v_cvt_pk_bf16_f32 v83, v22, v23
    v_exp_f32 v25, v25
    v_exp_f32 v26, v26
    v_mfma_f32_32x32x16_bf16 v[88:103], v[136:139], v[80:83], v[88:103]
    ds_read_b128 v[136:139], v4 offset:1408
    v_exp_f32 v27, v27
    v_exp_f32 v28, v28
    v_exp_f32 v29, v29
    v_cvt_pk_bf16_f32 v84, v24, v25
    v_exp_f32 v30, v30
    v_cvt_pk_bf16_f32 v85, v26, v27
    v_exp_f32 v31, v31
    v_cvt_pk_bf16_f32 v86, v28, v29
    v_cvt_pk_bf16_f32 v87, v30, v31
    s_setprio 2
    s_waitcnt lgkmcnt(0)
    v_mfma_f32_32x32x4_2b_bf16 v[48:79], v[134:135], v[124:125], v[48:79]
    ds_read_b64 v[134:135], v3 offset:5120
    ds_read_b32 v144, v12 offset:32
    v_exp_f32 v32, v32
    v_exp_f32 v33, v33
    v_exp_f32 v34, v34
    v_exp_f32 v35, v35
    v_mfma_f32_32x32x16_bf16 v[88:103], v[140:143], v[84:87], v[88:103]
    ds_read_b128 v[140:143], v4 offset:2112
    v_cvt_pk_bf16_f32 v80, v32, v33
    v_exp_f32 v36, v36
    v_cvt_pk_bf16_f32 v81, v34, v35
    v_exp_f32 v37, v37
    v_exp_f32 v38, v38
    v_exp_f32 v39, v39
    v_cvt_pk_bf16_f32 v82, v36, v37
    v_exp_f32 v40, v40
    v_cvt_pk_bf16_f32 v83, v38, v39
    v_exp_f32 v41, v41
    v_exp_f32 v42, v42
    v_mfma_f32_32x32x16_bf16 v[88:103], v[136:139], v[80:83], v[88:103]
    ds_read_b128 v[136:139], v4 offset:2816
    v_exp_f32 v43, v43
    v_exp_f32 v44, v44
    v_exp_f32 v45, v45
    v_cvt_pk_bf16_f32 v84, v40, v41
    v_exp_f32 v46, v46
    v_cvt_pk_bf16_f32 v85, v42, v43
    v_exp_f32 v47, v47
    v_cvt_pk_bf16_f32 v86, v44, v45
    v_cvt_pk_bf16_f32 v87, v46, v47
    s_setprio 1
    s_waitcnt lgkmcnt(0)
    s_waitcnt vmcnt(0)
    s_add_u32 s31, s18, 2
    v_mov_b32 v145, s31
    ds_write_b32 v13, v145
    v_mfma_f32_32x32x16_bf16 v[16:31], v[126:129], v[120:123], v[104:119]
    ds_read_b128 v[126:129], v2 offset:7680
    v_exp_f32 v48, v48
    v_exp_f32 v49, v49
    v_exp_f32 v50, v50
    v_exp_f32 v51, v51
    v_mfma_f32_32x32x16_bf16 v[88:103], v[140:143], v[84:87], v[88:103]
    ds_read_b128 v[140:143], v4 offset:3520
    s_cmp_lt_u32 s18, 6
    s_cbranch_scc0 Lk2skip_10008
    v_cmp_le_u32 vcc, s18, v144
    s_cmp_eq_u64 vcc, exec
    s_cbranch_scc1 Lfree_10009
    s_mov_b32 s34, 0x40000
Lfree_10009_s:
    s_sub_u32 s34, s34, 1
    s_cbranch_scc1 Lfree_10009
    s_sleep 1
    ds_read_b32 v144, v12 offset:32
    s_waitcnt lgkmcnt(0)
    v_cmp_le_u32 vcc, s18, v144
    s_cmp_eq_u64 vcc, exec
    s_cbranch_scc0 Lfree_10009_s
Lfree_10009:
    s_add_u32 s30, s27, s25
    s_add_u32 m0, s30, 0
    s_add_u32 s26, s17, 0
    buffer_load_dwordx4 v8, s[8:11], s26 offen lds
    s_add_u32 m0, s30, 1024
    s_add_u32 s26, s17, 1024
    buffer_load_dwordx4 v8, s[8:11], s26 offen lds
    s_add_u32 m0, s30, 2048
    s_add_u32 s26, s17, 2048
    buffer_load_dwordx4 v8, s[8:11], s26 offen lds
    s_add_u32 s17, s17, 21504
Lk2skip_10008:
    v_cvt_pk_bf16_f32 v80, v48, v49
    v_exp_f32 v52, v52
    v_cvt_pk_bf16_f32 v81, v50, v51
    v_exp_f32 v53, v53
    v_exp_f32 v54, v54
    v_exp_f32 v55, v55
    v_mfma_f32_32x32x16_bf16 v[32:47], v[130:133], v[120:123], v[104:119]
    ds_read_b128 v[130:133], v2 offset:8960
    v_cvt_pk_bf16_f32 v82, v52, v53
    v_exp_f32 v56, v56
    v_cvt_pk_bf16_f32 v83, v54, v55
    v_exp_f32 v57, v57
    v_exp_f32 v58, v58
    v_mfma_f32_32x32x16_bf16 v[88:103], v[136:139], v[80:83], v[88:103]
    ds_read_b128 v[136:139], v4 offset:4224
    v_exp_f32 v59, v59
    v_exp_f32 v60, v60
    v_exp_f32 v61, v61
    v_cvt_pk_bf16_f32 v84, v56, v57
    v_exp_f32 v62, v62
    v_cvt_pk_bf16_f32 v85, v58, v59
    v_exp_f32 v63, v63
    v_cvt_pk_bf16_f32 v86, v60, v61
    v_cvt_pk_bf16_f32 v87, v62, v63
    s_setprio 0
    s_waitcnt lgkmcnt(0)
    v_mfma_f32_32x32x4_2b_bf16 v[16:47], v[134:135], v[124:125], v[16:47]
    ds_read_b64 v[134:135], v3 offset:7680
    ds_read_b32 v145, v12
    v_exp_f32 v64, v64
    v_exp_f32 v65, v65
    v_exp_f32 v66, v66
    v_exp_f32 v67, v67
    v_mfma_f32_32x32x16_bf16 v[88:103], v[140:143], v[84:87], v[88:103]
    ds_read_b128 v[140:143], v4 offset:4928
    v_cvt_pk_bf16_f32 v80, v64, v65
    v_exp_f32 v68, v68
    v_cvt_pk_bf16_f32 v81, v66, v67
    v_exp_f32 v69, v69
    v_exp_f32 v70, v70
    v_exp_f32 v71, v71
    v_cvt_pk_bf16_f32 v82, v68, v69
    v_exp_f32 v72, v72
    v_cvt_pk_bf16_f32 v83, v70, v71
    v_exp_f32 v73, v73
    v_exp_f32 v74, v74
    v_mfma_f32_32x32x16_bf16 v[88:103], v[136:139], v[80:83], v[88:103]
    ds_read_b128 v[136:139], v4 offset:5632
    v_exp_f32 v75, v75
    v_exp_f32 v76, v76
    v_exp_f32 v77, v77
    v_cvt_pk_bf16_f32 v84, v72, v73
    v_exp_f32 v78, v78
    v_cvt_pk_bf16_f32 v85, v74, v75
    v_exp_f32 v79, v79
    v_cvt_pk_bf16_f32 v86, v76, v77
    v_cvt_pk_bf16_f32 v87, v78, v79
    s_setprio 3
    s_waitcnt lgkmcnt(0)
    s_cmp_lt_u32 s18, 7
    s_cbranch_scc0 Lnofull_10010
    s_add_u32 s31, s18, 2
    v_cmp_le_u32 vcc, s31, v145
    s_cmp_eq_u64 vcc, exec
    s_cbranch_scc1 Lfull_10011
    s_mov_b32 s34, 0x40000
Lfull_10011_s:
    s_sub_u32 s34, s34, 1
    s_cbranch_scc1 Lfull_10011
    s_sleep 1
    ds_read_b32 v145, v12 offset:0
    s_waitcnt lgkmcnt(0)
    v_cmp_le_u32 vcc, s31, v145
    s_cmp_eq_u64 vcc, exec
    s_cbranch_scc0 Lfull_10011_s
Lfull_10011:
Lnofull_10010:
    v_add_u32 v2, s19, v5
    v_add_u32 v3, s19, v6
    v_mfma_f32_32x32x16_bf16 v[48:63], v[126:129], v[120:123], v[104:119]
    ds_read_b128 v[126:129], v2 offset:0
    v_exp_f32 v16, v16
    v_exp_f32 v17, v17
    v_exp_f32 v18, v18
    v_exp_f32 v19, v19
    v_mfma_f32_32x32x16_bf16 v[88:103], v[140:143], v[84:87], v[88:103]
    ds_read_b128 v[140:143], v4 offset:6336
    v_cvt_pk_bf16_f32 v80, v16, v17
    v_exp_f32 v20, v20
    v_cvt_pk_bf16_f32 v81, v18, v19
    v_exp_f32 v21, v21
    v_exp_f32 v22, v22
    v_exp_f32 v23, v23
    v_mfma_f32_32x32x16_bf16 v[64:79], v[130:133], v[120:123], v[104:119]
    ds_read_b128 v[130:133], v2 offset:1280
    v_cvt_pk_bf16_f32 v82, v20, v21
    v_exp_f32 v24, v24
    v_cvt_pk_bf16_f32 v83, v22, v23
    v_exp_f32 v25, v25
    v_exp_f32 v26, v26
    v_mfma_f32_32x32x16_bf16 v[88:103], v[136:139], v[80:83], v[88:103]
    ds_read_b128 v[136:139], v4 offset:7040
    v_exp_f32 v27, v27
    v_exp_f32 v28, v28
    v_exp_f32 v29, v29
    v_cvt_pk_bf16_f32 v84, v24, v25
    v_exp_f32 v30, v30
    v_cvt_pk_bf16_f32 v85, v26, v27
    v_exp_f32 v31, v31
    v_cvt_pk_bf16_f32 v86, v28, v29
    v_cvt_pk_bf16_f32 v87, v30, v31
    s_setprio 2
    s_waitcnt lgkmcnt(0)
    v_mfma_f32_32x32x4_2b_bf16 v[48:79], v[134:135], v[124:125], v[48:79]
    ds_read_b64 v[134:135], v3 offset:0
    v_exp_f32 v32, v32
    v_exp_f32 v33, v33
    v_exp_f32 v34, v34
    v_exp_f32 v35, v35
    v_mfma_f32_32x32x16_bf16 v[88:103], v[140:143], v[84:87], v[88:103]
    ds_read_b128 v[140:143], v4 offset:7744
    v_cvt_pk_bf16_f32 v80, v32, v33
    v_exp_f32 v36, v36
    v_cvt_pk_bf16_f32 v81, v34, v35
    v_exp_f32 v37, v37
    v_exp_f32 v38, v38
    v_exp_f32 v39, v39
    v_cvt_pk_bf16_f32 v82, v36, v37
    v_exp_f32 v40, v40
    v_cvt_pk_bf16_f32 v83, v38, v39
    v_exp_f32 v41, v41
    v_exp_f32 v42, v42
    v_mfma_f32_32x32x16_bf16 v[88:103], v[136:139], v[80:83], v[88:103]
    ds_read_b128 v[136:139], v4 offset:8448
    v_exp_f32 v43, v43
    v_exp_f32 v44, v44
    v_exp_f32 v45, v45
    v_cvt_pk_bf16_f32 v84, v40, v41
    v_exp_f32 v46, v46
    v_cvt_pk_bf16_f32 v85, v42, v43
    v_exp_f32 v47, v47
    v_cvt_pk_bf16_f32 v86, v44, v45
    v_cvt_pk_bf16_f32 v87, v46, v47
    s_setprio 1
    s_waitcnt lgkmcnt(0)
    v_mfma_f32_32x32x16_bf16 v[16:31], v[126:129], v[120:123], v[104:119]
    ds_read_b128 v[126:129], v2 offset:2560
    v_exp_f32 v48, v48
    v_exp_f32 v49, v49
    v_exp_f32 v50, v50
    v_exp_f32 v51, v51
    v_mfma_f32_32x32x16_bf16 v[88:103], v[140:143], v[84:87], v[88:103]
    ds_read_b128 v[140:143], v4 offset:9152
    v_cvt_pk_bf16_f32 v80, v48, v49
    v_exp_f32 v52, v52
    v_cvt_pk_bf16_f32 v81, v50, v51
    v_exp_f32 v53, v53
    v_exp_f32 v54, v54
    v_exp_f32 v55, v55
    v_mfma_f32_32x32x16_bf16 v[32:47], v[130:133], v[120:123], v[104:119]
    ds_read_b128 v[130:133], v2 offset:3840
    v_cvt_pk_bf16_f32 v82, v52, v53
    v_exp_f32 v56, v56
    v_cvt_pk_bf16_f32 v83, v54, v55
    v_exp_f32 v57, v57
    v_exp_f32 v58, v58
    v_mfma_f32_32x32x16_bf16 v[88:103], v[136:139], v[80:83], v[88:103]
    ds_read_b128 v[136:139], v4 offset:9856
    v_exp_f32 v59, v59
    v_exp_f32 v60, v60
    v_exp_f32 v61, v61
    v_cvt_pk_bf16_f32 v84, v56, v57
    v_exp_f32 v62, v62
    v_cvt_pk_bf16_f32 v85, v58, v59
    v_exp_f32 v63, v63
    v_cvt_pk_bf16_f32 v86, v60, v61
    v_cvt_pk_bf16_f32 v87, v62, v63
    s_setprio 0
    s_waitcnt lgkmcnt(0)
    v_mfma_f32_32x32x4_2b_bf16 v[16:47], v[134:135], v[124:125], v[16:47]
    ds_read_b64 v[134:135], v3 offset:2560
    v_exp_f32 v64, v64
    v_exp_f32 v65, v65
    v_exp_f32 v66, v66
    v_exp_f32 v67, v67
    v_mfma_f32_32x32x16_bf16 v[88:103], v[140:143], v[84:87], v[88:103]
    ds_read_b128 v[140:143], v4 offset:10560
    v_add_u32 v4, s19, v7
    v_cvt_pk_bf16_f32 v80, v64, v65
    v_exp_f32 v68, v68
    v_cvt_pk_bf16_f32 v81, v66, v67
    v_exp_f32 v69, v69
    v_exp_f32 v70, v70
    v_exp_f32 v71, v71
    v_cvt_pk_bf16_f32 v82, v68, v69
    v_exp_f32 v72, v72
    v_cvt_pk_bf16_f32 v83, v70, v71
    v_exp_f32 v73, v73
    v_exp_f32 v74, v74
    v_mfma_f32_32x32x16_bf16 v[88:103], v[136:139], v[80:83], v[88:103]
    ds_read_b128 v[136:139], v4 offset:0
    v_exp_f32 v75, v75
    v_exp_f32 v76, v76
    v_exp_f32 v77, v77
    v_cvt_pk_bf16_f32 v84, v72, v73
    v_exp_f32 v78, v78
    v_cvt_pk_bf16_f32 v85, v74, v75
    v_exp_f32 v79, v79
    v_cvt_pk_bf16_f32 v86, v76, v77
    v_cvt_pk_bf16_f32 v87, v78, v79
    s_mov_b32 s19, s27
    s_add_u32 s27, s27, 24576
    s_cmp_ge_u32 s27, 73728
    s_cselect_b32 s27, 0, s27
    s_add_u32 s18, s18, 1
    s_cmp_lt_u32 s18, 8
    s_cbranch_scc1 Lk2_loop
    s_waitcnt lgkmcnt(0)
    v_mfma_f32_32x32x16_bf16 v[88:103], v[140:143], v[84:87], v[88:103]
    s_mov_b32 s31, 0
    s_nop 15
Lk2_fin:
    v_mov_b32 v9, v96
    v_mov_b32 v10, v96
    s_nop 1
    v_permlane32_swap_b32 v9, v10
    s_nop 1
    v_mul_f32 v11, 0, v88
    v_fma_f32 v11, v89, 0, v11
    v_fma_f32 v11, v90, 0, v11
    v_fma_f32 v11, v91, 0, v11
    v_fma_f32 v11, v92, 0, v11
    v_fma_f32 v11, v93, 0, v11
    v_fma_f32 v11, v94, 0, v11
    v_fma_f32 v11, v95, 0, v11
    v_mul_f32 v14, 0, v96
    v_fma_f32 v14, v97, 0, v14
    v_fma_f32 v14, v98, 0, v14
    v_fma_f32 v14, v99, 0, v14
    v_cndmask_b32 v14, 0, v14, s[28:29]
    v_add_f32 v11, v11, v14
    v_add_f32 v11, v11, v10
    v_mov_b32 v15, 0x53800000
    v_cmp_nlt_f32 vcc, v11, v15
    s_cmp_eq_u32 s31, 0
    s_cbranch_scc0 Lk2_store
    s_cbranch_vccnz Lk2_fallback
Lk2_store:
    v_rcp_f32 v10, v10
    s_mul_i32 s21, s15, 40960
    s_add_u32 s21, s21, 14680064
    v_mov_b32 v11, v10
    v_pk_mul_f32 v[88:89], v[88:89], v[10:11]
    v_pk_mul_f32 v[90:91], v[90:91], v[10:11]
    v_pk_mul_f32 v[92:93], v[92:93], v[10:11]
    v_pk_mul_f32 v[94:95], v[94:95], v[10:11]
    v_pk_mul_f32 v[96:97], v[96:97], v[10:11]
    v_pk_mul_f32 v[98:99], v[98:99], v[10:11]
    v_cvt_pk_bf16_f32 v16, v88, v89
    v_cvt_pk_bf16_f32 v17, v90, v91
    v_cvt_pk_bf16_f32 v18, v92, v93
    v_cvt_pk_bf16_f32 v19, v94, v95
    v_cvt_pk_bf16_f32 v20, v96, v97
    v_cvt_pk_bf16_f32 v21, v98, v99
    buffer_store_dwordx4 v[16:19], v152, s[8:11], s21 offen sc1
    s_mov_b64 exec, s[28:29]
    buffer_store_dwordx2 v[20:21], v153, s[8:11], s21 offen sc1
    s_mov_b64 exec, -1
    s_waitcnt vmcnt(0)
    s_barrier
    s_cmp_eq_u32 s12, 0
    s_cbranch_scc0 Lk2_nopub
    s_mul_i32 s20, s14, 4352
    s_lshl_b32 s21, s13, 2
    s_add_u32 s20, s20, s21
    s_add_u32 s20, s20, 24903680
    v_mov_b32 v16, 155772
    s_mov_b32 s99, 0x100000
Ltag_10012:
    ds_read_b32 v17, v16
    s_waitcnt lgkmcnt(0)
    v_readfirstlane_b32 s21, v17
    s_nop 3
    s_cmp_lg_u32 s21, 0
    s_cbranch_scc1 Ltag_10012_ok
    s_sleep 2
    s_sub_u32 s99, s99, 1
    s_cbranch_scc0 Ltag_10012
Ltag_10012_ok:
    v_mov_b32 v16, s21
    v_mul_u32_u24 v17, 34816, v1
    s_mov_b64 exec, 0x1
    buffer_store_dword v16, v17, s[8:11], s20 offen sc1
    s_mov_b64 exec, -1
Lk2_nopub:
    s_endpgm
Lk2_fallback:
    s_mov_b32 s31, 1
    v_and_b32 v9, 31, v1
    v_lshlrev_b32 v11, 3, v9
    v_add_u32 v11, 1024, v11
    v_mov_b32 v14, 0xff800000
    s_mov_b32 s18, 0
Lk2_fb1:
    s_lshr_b32 s20, s18, 3
    s_mul_i32 s20, s20, 21504
    s_and_b32 s21, s18, 7
    s_mul_i32 s21, s21, 1280
    s_add_u32 s20, s20, s21
    s_add_u32 s20, s20, s16
    buffer_load_dwordx4 v[126:129], v8, s[8:11], s20 offen
    buffer_load_dwordx2 v[134:135], v11, s[8:11], s20 offen
    s_waitcnt vmcnt(0)
    v_mfma_f32_32x32x16_bf16 v[16:31], v[126:129], v[120:123], 0
    v_mfma_f32_32x32x16_bf16 v[32:47], v[126:129], v[120:123], 0
    s_nop 11
    v_mfma_f32_32x32x4_2b_bf16 v[16:47], v[134:135], v[124:125], v[16:47]
    s_nop 15
    s_nop 7
    v_max3_f32 v14, v14, v16, v17
    v_max3_f32 v14, v14, v18, v19
    v_max3_f32 v14, v14, v20, v21
    v_max3_f32 v14, v14, v22, v23
    v_max3_f32 v14, v14, v24, v25
    v_max3_f32 v14, v14, v26, v27
    v_max3_f32 v14, v14, v28, v29
    v_max3_f32 v14, v14, v30, v31
    s_add_u32 s18, s18, 1
    s_cmp_lt_u32 s18, 64
    s_cbranch_scc1 Lk2_fb1
    v_mov_b32 v15, v14
    s_nop 1
    v_permlane32_swap_b32 v14, v15
    s_nop 1
    v_max_f32 v14, v14, v15
    v_mov_b32 v88, 0
    v_mov_b32 v89, 0
    v_mov_b32 v90, 0
    v_mov_b32 v91, 0
    v_mov_b32 v92, 0
    v_mov_b32 v93, 0
    v_mov_b32 v94, 0
    v_mov_b32 v95, 0
    v_mov_b32 v96, 0
    v_mov_b32 v97, 0
    v_mov_b32 v98, 0
    v_mov_b32 v99, 0
    v_mov_b32 v100, 0
    v_mov_b32 v101, 0
    v_mov_b32 v102, 0
    v_mov_b32 v103, 0
    s_mov_b32 s18, 0
Lk2_fb2:
    s_lshr_b32 s20, s18, 3
    s_mul_i32 s20, s20, 21504
    s_and_b32 s21, s18, 7
    s_mul_i32 s22, s21, 1408
    s_add_u32 s22, s22, s20
    s_add_u32 s22, s22, s16
    s_mul_i32 s21, s21, 1280
    s_add_u32 s20, s20, s21
    s_add_u32 s20, s20, s16
    buffer_load_dwordx4 v[126:129], v8, s[8:11], s20 offen
    buffer_load_dwordx2 v[134:135], v11, s[8:11], s20 offen
    buffer_load_dwordx4 v[136:139], v7, s[8:11], s22 offen
    buffer_load_dwordx4 v[140:143], v7, s[8:11], s22 offen offset:704
    s_waitcnt vmcnt(0)
    v_mfma_f32_32x32x16_bf16 v[16:31], v[126:129], v[120:123], 0
    v_mfma_f32_32x32x16_bf16 v[32:47], v[126:129], v[120:123], 0
    s_nop 11
    v_mfma_f32_32x32x4_2b_bf16 v[16:47], v[134:135], v[124:125], v[16:47]
    s_nop 15
    s_nop 7
    v_sub_f32 v16, v16, v14
    v_sub_f32 v17, v17, v14
    v_sub_f32 v18, v18, v14
    v_sub_f32 v19, v19, v14
    v_sub_f32 v20, v20, v14
    v_sub_f32 v21, v21, v14
    v_sub_f32 v22, v22, v14
    v_sub_f32 v23, v23, v14
    v_sub_f32 v24, v24, v14
    v_sub_f32 v25, v25, v14
    v_sub_f32 v26, v26, v14
    v_sub_f32 v27, v27, v14
    v_sub_f32 v28, v28, v14
    v_sub_f32 v29, v29, v14
    v_sub_f32 v30, v30, v14
    v_sub_f32 v31, v31, v14
    v_exp_f32 v16, v16
    v_exp_f32 v17, v17
    v_exp_f32 v18, v18
    v_exp_f32 v19, v19
    v_exp_f32 v20, v20
    v_exp_f32 v21, v21
    v_exp_f32 v22, v22
    v_exp_f32 v23, v23
    v_exp_f32 v24, v24
    v_exp_f32 v25, v25
    v_exp_f32 v26, v26
    v_exp_f32 v27, v27
    v_exp_f32 v28, v28
    v_exp_f32 v29, v29
    v_exp_f32 v30, v30
    v_exp_f32 v31, v31
    s_nop 0
    v_cvt_pk_bf16_f32 v80, v16, v17
    v_cvt_pk_bf16_f32 v81, v18, v19
    v_cvt_pk_bf16_f32 v82, v20, v21
    v_cvt_pk_bf16_f32 v83, v22, v23
    v_cvt_pk_bf16_f32 v84, v24, v25
    v_cvt_pk_bf16_f32 v85, v26, v27
    v_cvt_pk_bf16_f32 v86, v28, v29
    v_cvt_pk_bf16_f32 v87, v30, v31
    s_nop 1
    v_mfma_f32_32x32x16_bf16 v[88:103], v[136:139], v[80:83], v[88:103]
    v_mfma_f32_32x32x16_bf16 v[88:103], v[140:143], v[84:87], v[88:103]
    s_add_u32 s18, s18, 1
    s_cmp_lt_u32 s18, 64
    s_cbranch_scc1 Lk2_fb2
    s_nop 15
    s_branch Lk2_fin
Lk2_end:
    s_endpgm
Lk2_shadow:
    s_setprio 0
    s_load_dwordx2 s[30:31], s[0:1], 64
    s_sub_u32 s40, s12, 8
    s_lshr_b32 s41, s13, 3
    s_lshl_b32 s44, s14, 2
    s_add_u32 s44, s44, s41
    s_and_b32 s43, s13, 7
    s_lshl_b32 s46, s44, 2
    s_add_u32 s46, s46, s40
    s_mul_i32 s47, s40, 5120
    s_mul_i32 s49, s43, 348160
    s_add_u32 s49, s49, s47
    s_add_u32 s49, s49, 17825792
    s_add_u32 s47, s47, 73728
    s_mul_i32 s51, s46, 49152
    s_add_u32 s51, s51, 8388608
    s_mul_i32 s52, s46, 20480
    s_add_u32 s52, s52, 14680064
    v_lshlrev_b32 v2, 4, v1
    v_add_u32 v3, 73728, v2
    v_add_u32 v0, 135168, v2
    v_and_b32 v4, 3, v1
    v_lshlrev_b32 v4, 2, v4
    v_add_u32 v4, 155712, v4
    s_lshl_b32 s53, s40, 2
    s_add_u32 s53, s53, 155712
    v_mov_b32 v5, s53
    s_waitcnt lgkmcnt(0)
    s_mov_b32 s8, s4
    s_and_b32 s9, s5, 0xffff
    s_mov_b32 s10, 33554432
    s_mov_b32 s11, 0x00020000
    s_mov_b32 s24, s30
    s_and_b32 s25, s31, 0xffff
    s_mov_b32 s26, 2621440
    s_mov_b32 s27, 0x00020000
    v_mov_b32 v8, 0
    v_mov_b32 v9, 0
    v_mov_b32 v10, 0
    v_mov_b32 v11, 0
    v_mov_b32 v12, 0
    v_mov_b32 v13, 0
    v_mov_b32 v14, 0
    v_mov_b32 v15, 0
    v_mov_b32 v16, 0
    v_mov_b32 v17, 0
    v_mov_b32 v18, 0
    v_mov_b32 v19, 0
    v_mov_b32 v20, 0
    v_mov_b32 v21, 0
    v_mov_b32 v22, 0
    v_mov_b32 v23, 0
    v_mov_b32 v24, 0
    v_mov_b32 v25, 0
    v_mov_b32 v26, 0
    v_mov_b32 v27, 0
    v_mov_b32 v28, 0
    v_mov_b32 v29, 0
    v_mov_b32 v30, 0
    v_mov_b32 v31, 0
    v_mov_b32 v32, 0
    v_mov_b32 v33, 0
    v_mov_b32 v34, 0
    v_mov_b32 v35, 0
    v_mov_b32 v36, 0
    v_mov_b32 v37, 0
    v_mov_b32 v38, 0
    v_mov_b32 v39, 0
    v_mov_b32 v40, 0
    v_mov_b32 v41, 0
    v_mov_b32 v42, 0
    v_mov_b32 v43, 0
    v_mov_b32 v44, 0
    v_mov_b32 v45, 0
    v_mov_b32 v46, 0
    v_mov_b32 v47, 0
    s_cmp_eq_u32 s40, 0
    s_cbranch_scc0 Lsh_wgo2
    v_mbcnt_lo_u32_b32 v6, -1, 0
    v_mbcnt_hi_u32_b32 v6, -1, v6
    v_and_b32 v6, 3, v6
    v_lshlrev_b32 v6, 2, v6
    v_add_u32 v6, 155744, v6
    s_mov_b32 s99, 0x100000
Llsp_10013:
    ds_read_b32 v7, v6
    s_waitcnt lgkmcnt(0)
    v_cmp_le_u32 vcc, 1, v7
    s_nop 1
    s_cmp_eq_u64 vcc, exec
    s_cbranch_scc1 Llsp_10013_ok
    s_sleep 2
    s_sub_u32 s99, s99, 1
    s_cbranch_scc0 Llsp_10013
Llsp_10013_ok:
    v_mov_b32 v6, 155772
    s_mov_b32 s99, 0x100000
Ltag_10014:
    ds_read_b32 v7, v6
    s_waitcnt lgkmcnt(0)
    v_readfirstlane_b32 s62, v7
    s_nop 3
    s_cmp_lg_u32 s62, 0
    s_cbranch_scc1 Ltag_10014_ok
    s_sleep 2
    s_sub_u32 s99, s99, 1
    s_cbranch_scc0 Ltag_10014
Ltag_10014_ok:
    s_and_b32 s54, s2, 7
    s_lshr_b32 s55, s2, 3
    s_and_b32 s56, s54, 1
    s_lshl_b32 s56, s56, 3
    s_and_b32 s57, s55, 7
    s_add_u32 s56, s56, s57
    s_lshr_b32 s54, s54, 1
    s_lshl_b32 s54, s54, 2
    s_lshr_b32 s55, s55, 3
    s_add_u32 s54, s54, s55
    s_mul_i32 s56, s56, 4352
    s_lshl_b32 s54, s54, 2
    s_add_u32 s54, s54, s56
    s_add_u32 s54, s54, 24117248
    v_mul_u32_u24 v6, 69888, v1
    v_mov_b32 v7, s62
    s_mov_b64 exec, 0xf
    buffer_store_dword v7, v6, s[8:11], s54 offen sc1
    s_mov_b64 exec, -1
    v_mbcnt_lo_u32_b32 v6, -1, 0
    v_mbcnt_hi_u32_b32 v6, -1, v6
    v_lshlrev_b32 v7, 4, v6
    s_and_b32 s98, s2, 7
    s_mul_i32 s98, s98, 4352
    s_add_u32 s98, s98, 24772608
    s_mov_b32 s99, 0x40000
Lpl_10015:
    buffer_load_dwordx4 v[48:51], v7, s[8:11], s98 offen sc1
    s_waitcnt vmcnt(0)
    v_cmp_eq_u32 vcc, s62, v48
    v_cmp_eq_u32 s[96:97], s62, v49
    s_and_b64 vcc, vcc, s[96:97]
    v_cmp_eq_u32 s[96:97], s62, v50
    s_and_b64 vcc, vcc, s[96:97]
    v_cmp_eq_u32 s[96:97], s62, v51
    s_and_b64 vcc, vcc, s[96:97]
    s_cmp_eq_u64 vcc, exec
    s_cbranch_scc1 Lpl_10015_ok
    s_sleep 8
    s_sub_u32 s99, s99, 1
    s_cbranch_scc0 Lpl_10015
Lpl_10015_ok:
    s_lshr_b32 s54, s44, 1
    s_mul_i32 s54, s54, 4352
    s_lshr_b32 s55, s2, 3
    s_and_b32 s55, s55, 3
    s_mul_i32 s55, s55, 69888
    s_add_u32 s54, s54, s55
    s_add_u32 s54, s54, 24117248
    v_and_b32 v6, 15, v1
    v_lshlrev_b32 v6, 2, v6
    s_mov_b32 s60, 0x40000
Lsh_pb:
    buffer_load_dword v7, v6, s[8:11], s54 offen sc1
    s_waitcnt vmcnt(0)
    v_cmp_eq_u32 vcc, s62, v7
    s_cmp_eq_u64 vcc, exec
    s_cbranch_scc1 Lsh_pb_ok
    s_sleep 2
    s_sub_u32 s60, s60, 1
    s_cbranch_scc0 Lsh_pb
Lsh_pb_ok:
    v_mov_b32 v6, 155768
    v_mov_b32 v7, 1
    ds_write_b32 v6, v7
    s_branch Lsh_go2
Lsh_wgo2:
    v_mbcnt_lo_u32_b32 v6, -1, 0
    v_mbcnt_hi_u32_b32 v6, -1, v6
    v_and_b32 v6, 0, v6
    v_lshlrev_b32 v6, 2, v6
    v_add_u32 v6, 155768, v6
    s_mov_b32 s99, 0x100000
Llsp_10016:
    ds_read_b32 v7, v6
    s_waitcnt lgkmcnt(0)
    v_cmp_le_u32 vcc, 1, v7
    s_nop 1
    s_cmp_eq_u64 vcc, exec
    s_cbranch_scc1 Llsp_10016_ok
    s_sleep 4
    s_sub_u32 s99, s99, 1
    s_cbranch_scc0 Llsp_10016
Llsp_10016_ok:
Lsh_go2:
    s_add_u32 m0, s47, 0
    s_add_u32 s55, s49, 0
    buffer_load_dwordx4 v2, s[8:11], s55 offen lds
    s_add_u32 m0, s47, 1024
    s_add_u32 s55, s49, 1024
    buffer_load_dwordx4 v2, s[8:11], s55 offen lds
    s_add_u32 m0, s47, 2048
    s_add_u32 s55, s49, 2048
    buffer_load_dwordx4 v2, s[8:11], s55 offen lds
    s_add_u32 m0, s47, 3072
    s_add_u32 s55, s49, 3072
    buffer_load_dwordx4 v2, s[8:11], s55 offen lds
    s_add_u32 m0, s47, 4096
    s_add_u32 s55, s49, 4096
    buffer_load_dwordx4 v2, s[8:11], s55 offen lds
    s_add_u32 s55, s51, 0
    buffer_load_dwordx4 v[88:91], v2, s[8:11], s55 offen
    s_add_u32 s55, s51, 1024
    buffer_load_dwordx4 v[92:95], v2, s[8:11], s55 offen
    s_add_u32 s55, s51, 2048
    buffer_load_dwordx4 v[96:99], v2, s[8:11], s55 offen
    s_add_u32 s55, s51, 3072
    buffer_load_dwordx4 v[100:103], v2, s[8:11], s55 offen
    s_add_u32 m0, s47, 20480
    s_add_u32 s55, s49, 20480
    buffer_load_dwordx4 v2, s[8:11], s55 offen lds
    s_add_u32 m0, s47, 21504
    s_add_u32 s55, s49, 21504
    buffer_load_dwordx4 v2, s[8:11], s55 offen lds
    s_add_u32 m0, s47, 22528
    s_add_u32 s55, s49, 22528
    buffer_load_dwordx4 v2, s[8:11], s55 offen lds
    s_add_u32 m0, s47, 23552
    s_add_u32 s55, s49, 23552
    buffer_load_dwordx4 v2, s[8:11], s55 offen lds
    s_add_u32 m0, s47, 24576
    s_add_u32 s55, s49, 24576
    buffer_load_dwordx4 v2, s[8:11], s55 offen lds
    s_add_u32 s55, s51, 4096
    buffer_load_dwordx4 v[104:107], v2, s[8:11], s55 offen
    s_add_u32 s55, s51, 5120
    buffer_load_dwordx4 v[108:111], v2, s[8:11], s55 offen
    s_add_u32 s55, s51, 6144
    buffer_load_dwordx4 v[112:115], v2, s[8:11], s55 offen
    s_add_u32 s55, s51, 7168
    buffer_load_dwordx4 v[116:119], v2, s[8:11], s55 offen
    s_add_u32 m0, s47, 40960
    s_add_u32 s55, s49, 40960
    buffer_load_dwordx4 v2, s[8:11], s55 offen lds
    s_add_u32 m0, s47, 41984
    s_add_u32 s55, s49, 41984
    buffer_load_dwordx4 v2, s[8:11], s55 offen lds
    s_add_u32 m0, s47, 43008
    s_add_u32 s55, s49, 43008
    buffer_load_dwordx4 v2, s[8:11], s55 offen lds
    s_add_u32 m0, s47, 44032
    s_add_u32 s55, s49, 44032
    buffer_load_dwordx4 v2, s[8:11], s55 offen lds
    s_add_u32 m0, s47, 45056
    s_add_u32 s55, s49, 45056
    buffer_load_dwordx4 v2, s[8:11], s55 offen lds
    s_add_u32 s55, s51, 8192
    buffer_load_dwordx4 v[120:123], v2, s[8:11], s55 offen
    s_add_u32 s55, s51, 9216
    buffer_load_dwordx4 v[124:127], v2, s[8:11], s55 offen
    s_add_u32 s55, s51, 10240
    buffer_load_dwordx4 v[128:131], v2, s[8:11], s55 offen
    s_add_u32 s55, s51, 11264
    buffer_load_dwordx4 v[132:135], v2, s[8:11], s55 offen
    s_waitcnt vmcnt(18) lgkmcnt(0)
    v_mov_b32 v6, 1
    ds_write_b32 v5, v6
    s_mov_b32 s60, 0x40000
Lshs_10017:
    ds_read_b32 v7, v4
    s_waitcnt lgkmcnt(0)
    v_cmp_le_u32 vcc, 1, v7
    s_cmp_eq_u64 vcc, exec
    s_cbranch_scc1 Lshs_10017_ok
    s_sleep 2
    s_sub_u32 s60, s60, 1
    s_cbranch_scc0 Lshs_10017
Lshs_10017_ok:
    ds_read_b128 v[48:51], v3 offset:0
    ds_read_b128 v[52:55], v3 offset:1024
    ds_read_b128 v[56:59], v3 offset:2048
    ds_read_b128 v[60:63], v3 offset:3072
    ds_read_b128 v[64:67], v3 offset:4096
    ds_read_b128 v[68:71], v3 offset:5120
    ds_read_b128 v[72:75], v3 offset:6144
    ds_read_b128 v[76:79], v3 offset:7168
    ds_read_b128 v[80:83], v3 offset:8192
    ds_read_b128 v[84:87], v3 offset:9216
    s_waitcnt lgkmcnt(5)
    v_mfma_f32_16x16x32_bf16 v[8:11], v[48:51], v[88:91], v[8:11]
    v_mfma_f32_16x16x32_bf16 v[12:15], v[52:55], v[88:91], v[12:15]
    v_mfma_f32_16x16x32_bf16 v[16:19], v[56:59], v[88:91], v[16:19]
    v_mfma_f32_16x16x32_bf16 v[20:23], v[60:63], v[88:91], v[20:23]
    v_mfma_f32_16x16x32_bf16 v[24:27], v[64:67], v[88:91], v[24:27]
    s_add_u32 m0, s47, 61440
    s_add_u32 s55, s49, 61440
    buffer_load_dwordx4 v2, s[8:11], s55 offen lds
    s_add_u32 m0, s47, 62464
    s_add_u32 s55, s49, 62464
    buffer_load_dwordx4 v2, s[8:11], s55 offen lds
    s_add_u32 m0, s47, 63488
    s_add_u32 s55, s49, 63488
    buffer_load_dwordx4 v2, s[8:11], s55 offen lds
    ds_read_b128 v[48:51], v3 offset:10240
    ds_read_b128 v[52:55], v3 offset:11264
    ds_read_b128 v[56:59], v3 offset:12288
    ds_read_b128 v[60:63], v3 offset:13312
    ds_read_b128 v[64:67], v3 offset:14336
    s_waitcnt lgkmcnt(5)
    v_mfma_f32_16x16x32_bf16 v[8:11], v[68:71], v[92:95], v[8:11]
    v_mfma_f32_16x16x32_bf16 v[12:15], v[72:75], v[92:95], v[12:15]
    v_mfma_f32_16x16x32_bf16 v[16:19], v[76:79], v[92:95], v[16:19]
    v_mfma_f32_16x16x32_bf16 v[20:23], v[80:83], v[92:95], v[20:23]
    v_mfma_f32_16x16x32_bf16 v[24:27], v[84:87], v[92:95], v[24:27]
    s_add_u32 m0, s47, 64512
    s_add_u32 s55, s49, 64512
    buffer_load_dwordx4 v2, s[8:11], s55 offen lds
    s_add_u32 m0, s47, 65536
    s_add_u32 s55, s49, 65536
    buffer_load_dwordx4 v2, s[8:11], s55 offen lds
    s_add_u32 s55, s51, 12288
    buffer_load_dwordx4 v[136:139], v2, s[8:11], s55 offen
    ds_read_b128 v[68:71], v3 offset:15360
    ds_read_b128 v[72:75], v3 offset:16384
    ds_read_b128 v[76:79], v3 offset:17408
    ds_read_b128 v[80:83], v3 offset:18432
    ds_read_b128 v[84:87], v3 offset:19456
    s_waitcnt lgkmcnt(5)
    v_mfma_f32_16x16x32_bf16 v[8:11], v[48:51], v[96:99], v[8:11]
    v_mfma_f32_16x16x32_bf16 v[12:15], v[52:55], v[96:99], v[12:15]
    v_mfma_f32_16x16x32_bf16 v[16:19], v[56:59], v[96:99], v[16:19]
    v_mfma_f32_16x16x32_bf16 v[20:23], v[60:63], v[96:99], v[20:23]
    v_mfma_f32_16x16x32_bf16 v[24:27], v[64:67], v[96:99], v[24:27]
    s_add_u32 s55, s51, 13312
    buffer_load_dwordx4 v[140:143], v2, s[8:11], s55 offen
    s_add_u32 s55, s51, 14336
    buffer_load_dwordx4 v[144:147], v2, s[8:11], s55 offen
    s_add_u32 s55, s51, 15360
    buffer_load_dwordx4 v[148:151], v2, s[8:11], s55 offen
    s_waitcnt lgkmcnt(0)
    v_mfma_f32_16x16x32_bf16 v[8:11], v[68:71], v[100:103], v[8:11]
    v_mfma_f32_16x16x32_bf16 v[12:15], v[72:75], v[100:103], v[12:15]
    v_mfma_f32_16x16x32_bf16 v[16:19], v[76:79], v[100:103], v[16:19]
    v_mfma_f32_16x16x32_bf16 v[20:23], v[80:83], v[100:103], v[20:23]
    v_mfma_f32_16x16x32_bf16 v[24:27], v[84:87], v[100:103], v[24:27]
    s_waitcnt vmcnt(18) lgkmcnt(0)
    v_mov_b32 v6, 2
    ds_write_b32 v5, v6
    s_mov_b32 s60, 0x40000
Lshs_10018:
    ds_read_b32 v7, v4
    s_waitcnt lgkmcnt(0)
    v_cmp_le_u32 vcc, 2, v7
    s_cmp_eq_u64 vcc, exec
    s_cbranch_scc1 Lshs_10018_ok
    s_sleep 2
    s_sub_u32 s60, s60, 1
    s_cbranch_scc0 Lshs_10018
Lshs_10018_ok:
    ds_read_b128 v[48:51], v3 offset:20480
    ds_read_b128 v[52:55], v3 offset:21504
    ds_read_b128 v[56:59], v3 offset:22528
    ds_read_b128 v[60:63], v3 offset:23552
    ds_read_b128 v[64:67], v3 offset:24576
    ds_read_b128 v[68:71], v3 offset:25600
    ds_read_b128 v[72:75], v3 offset:26624
    ds_read_b128 v[76:79], v3 offset:27648
    ds_read_b128 v[80:83], v3 offset:28672
    ds_read_b128 v[84:87], v3 offset:29696
    s_waitcnt lgkmcnt(5)
    v_mfma_f32_16x16x32_bf16 v[8:11], v[48:51], v[104:107], v[8:11]
    v_mfma_f32_16x16x32_bf16 v[12:15], v[52:55], v[104:107], v[12:15]
    v_mfma_f32_16x16x32_bf16 v[16:19], v[56:59], v[104:107], v[16:19]
    v_mfma_f32_16x16x32_bf16 v[20:23], v[60:63], v[104:107], v[20:23]
    v_mfma_f32_16x16x32_bf16 v[24:27], v[64:67], v[104:107], v[24:27]
    s_add_u32 m0, s47, 0
    s_add_u32 s55, s49, 81920
    buffer_load_dwordx4 v2, s[8:11], s55 offen lds
    s_add_u32 m0, s47, 1024
    s_add_u32 s55, s49, 82944
    buffer_load_dwordx4 v2, s[8:11], s55 offen lds
    s_add_u32 m0, s47, 2048
    s_add_u32 s55, s49, 83968
    buffer_load_dwordx4 v2, s[8:11], s55 offen lds
    ds_read_b128 v[48:51], v3 offset:30720
    ds_read_b128 v[52:55], v3 offset:31744
    ds_read_b128 v[56:59], v3 offset:32768
    ds_read_b128 v[60:63], v3 offset:33792
    ds_read_b128 v[64:67], v3 offset:34816
    s_waitcnt lgkmcnt(5)
    v_mfma_f32_16x16x32_bf16 v[8:11], v[68:71], v[108:111], v[8:11]
    v_mfma_f32_16x16x32_bf16 v[12:15], v[72:75], v[108:111], v[12:15]
    v_mfma_f32_16x16x32_bf16 v[16:19], v[76:79], v[108:111], v[16:19]
    v_mfma_f32_16x16x32_bf16 v[20:23], v[80:83], v[108:111], v[20:23]
    v_mfma_f32_16x16x32_bf16 v[24:27], v[84:87], v[108:111], v[24:27]
    s_add_u32 m0, s47, 3072
    s_add_u32 s55, s49, 84992
    buffer_load_dwordx4 v2, s[8:11], s55 offen lds
    s_add_u32 m0, s47, 4096
    s_add_u32 s55, s49, 86016
    buffer_load_dwordx4 v2, s[8:11], s55 offen lds
    s_add_u32 s55, s51, 16384
    buffer_load_dwordx4 v[88:91], v2, s[8:11], s55 offen
    ds_read_b128 v[68:71], v3 offset:35840
    ds_read_b128 v[72:75], v3 offset:36864
    ds_read_b128 v[76:79], v3 offset:37888
    ds_read_b128 v[80:83], v3 offset:38912
    ds_read_b128 v[84:87], v3 offset:39936
    s_waitcnt lgkmcnt(5)
    v_mfma_f32_16x16x32_bf16 v[8:11], v[48:51], v[112:115], v[8:11]
    v_mfma_f32_16x16x32_bf16 v[12:15], v[52:55], v[112:115], v[12:15]
    v_mfma_f32_16x16x32_bf16 v[16:19], v[56:59], v[112:115], v[16:19]
    v_mfma_f32_16x16x32_bf16 v[20:23], v[60:63], v[112:115], v[20:23]
    v_mfma_f32_16x16x32_bf16 v[24:27], v[64:67], v[112:115], v[24:27]
    s_add_u32 s55, s51, 17408
    buffer_load_dwordx4 v[92:95], v2, s[8:11], s55 offen
    s_add_u32 s55, s51, 18432
    buffer_load_dwordx4 v[96:99], v2, s[8:11], s55 offen
    s_add_u32 s55, s51, 19456
    buffer_load_dwordx4 v[100:103], v2, s[8:11], s55 offen
    s_waitcnt lgkmcnt(0)
    v_mfma_f32_16x16x32_bf16 v[8:11], v[68:71], v[116:119], v[8:11]
    v_mfma_f32_16x16x32_bf16 v[12:15], v[72:75], v[116:119], v[12:15]
    v_mfma_f32_16x16x32_bf16 v[16:19], v[76:79], v[116:119], v[16:19]
    v_mfma_f32_16x16x32_bf16 v[20:23], v[80:83], v[116:119], v[20:23]
    v_mfma_f32_16x16x32_bf16 v[24:27], v[84:87], v[116:119], v[24:27]
    s_waitcnt vmcnt(18) lgkmcnt(0)
    v_mov_b32 v6, 3
    ds_write_b32 v5, v6
    s_mov_b32 s60, 0x40000
Lshs_10019:
    ds_read_b32 v7, v4
    s_waitcnt lgkmcnt(0)
    v_cmp_le_u32 vcc, 3, v7
    s_cmp_eq_u64 vcc, exec
    s_cbranch_scc1 Lshs_10019_ok
    s_sleep 2
    s_sub_u32 s60, s60, 1
    s_cbranch_scc0 Lshs_10019
Lshs_10019_ok:
    ds_read_b128 v[48:51], v3 offset:40960
    ds_read_b128 v[52:55], v3 offset:41984
    ds_read_b128 v[56:59], v3 offset:43008
    ds_read_b128 v[60:63], v3 offset:44032
    ds_read_b128 v[64:67], v3 offset:45056
    ds_read_b128 v[68:71], v3 offset:46080
    ds_read_b128 v[72:75], v3 offset:47104
    ds_read_b128 v[76:79], v3 offset:48128
    ds_read_b128 v[80:83], v3 offset:49152
    ds_read_b128 v[84:87], v3 offset:50176
    s_waitcnt lgkmcnt(5)
    v_mfma_f32_16x16x32_bf16 v[8:11], v[48:51], v[120:123], v[8:11]
    v_mfma_f32_16x16x32_bf16 v[12:15], v[52:55], v[120:123], v[12:15]
    v_mfma_f32_16x16x32_bf16 v[16:19], v[56:59], v[120:123], v[16:19]
    v_mfma_f32_16x16x32_bf16 v[20:23], v[60:63], v[120:123], v[20:23]
    v_mfma_f32_16x16x32_bf16 v[24:27], v[64:67], v[120:123], v[24:27]
    s_add_u32 m0, s47, 20480
    s_add_u32 s55, s49, 102400
    buffer_load_dwordx4 v2, s[8:11], s55 offen lds
    s_add_u32 m0, s47, 21504
    s_add_u32 s55, s49, 103424
    buffer_load_dwordx4 v2, s[8:11], s55 offen lds
    s_add_u32 m0, s47, 22528
    s_add_u32 s55, s49, 104448
    buffer_load_dwordx4 v2, s[8:11], s55 offen lds
    ds_read_b128 v[48:51], v3 offset:51200
    ds_read_b128 v[52:55], v3 offset:52224
    ds_read_b128 v[56:59], v3 offset:53248
    ds_read_b128 v[60:63], v3 offset:54272
    ds_read_b128 v[64:67], v3 offset:55296
    s_waitcnt lgkmcnt(5)
    v_mfma_f32_16x16x32_bf16 v[8:11], v[68:71], v[124:127], v[8:11]
    v_mfma_f32_16x16x32_bf16 v[12:15], v[72:75], v[124:127], v[12:15]
    v_mfma_f32_16x16x32_bf16 v[16:19], v[76:79], v[124:127], v[16:19]
    v_mfma_f32_16x16x32_bf16 v[20:23], v[80:83], v[124:127], v[20:23]
    v_mfma_f32_16x16x32_bf16 v[24:27], v[84:87], v[124:127], v[24:27]
    s_add_u32 m0, s47, 23552
    s_add_u32 s55, s49, 105472
    buffer_load_dwordx4 v2, s[8:11], s55 offen lds
    s_add_u32 m0, s47, 24576
    s_add_u32 s55, s49, 106496
    buffer_load_dwordx4 v2, s[8:11], s55 offen lds
    s_add_u32 s55, s51, 20480
    buffer_load_dwordx4 v[104:107], v2, s[8:11], s55 offen
    ds_read_b128 v[68:71], v3 offset:56320
    ds_read_b128 v[72:75], v3 offset:57344
    ds_read_b128 v[76:79], v3 offset:58368
    ds_read_b128 v[80:83], v3 offset:59392
    ds_read_b128 v[84:87], v3 offset:60416
    s_waitcnt lgkmcnt(5)
    v_mfma_f32_16x16x32_bf16 v[8:11], v[48:51], v[128:131], v[8:11]
    v_mfma_f32_16x16x32_bf16 v[12:15], v[52:55], v[128:131], v[12:15]
    v_mfma_f32_16x16x32_bf16 v[16:19], v[56:59], v[128:131], v[16:19]
    v_mfma_f32_16x16x32_bf16 v[20:23], v[60:63], v[128:131], v[20:23]
    v_mfma_f32_16x16x32_bf16 v[24:27], v[64:67], v[128:131], v[24:27]
    s_add_u32 s55, s51, 21504
    buffer_load_dwordx4 v[108:111], v2, s[8:11], s55 offen
    s_add_u32 s55, s51, 22528
    buffer_load_dwordx4 v[112:115], v2, s[8:11], s55 offen
    s_add_u32 s55, s51, 23552
    buffer_load_dwordx4 v[116:119], v2, s[8:11], s55 offen
    s_waitcnt lgkmcnt(0)
    v_mfma_f32_16x16x32_bf16 v[8:11], v[68:71], v[132:135], v[8:11]
    v_mfma_f32_16x16x32_bf16 v[12:15], v[72:75], v[132:135], v[12:15]
    v_mfma_f32_16x16x32_bf16 v[16:19], v[76:79], v[132:135], v[16:19]
    v_mfma_f32_16x16x32_bf16 v[20:23], v[80:83], v[132:135], v[20:23]
    v_mfma_f32_16x16x32_bf16 v[24:27], v[84:87], v[132:135], v[24:27]
    s_waitcnt vmcnt(18) lgkmcnt(0)
    v_mov_b32 v6, 4
    ds_write_b32 v5, v6
    s_mov_b32 s60, 0x40000
Lshs_10020:
    ds_read_b32 v7, v4
    s_waitcnt lgkmcnt(0)
    v_cmp_le_u32 vcc, 4, v7
    s_cmp_eq_u64 vcc, exec
    s_cbranch_scc1 Lshs_10020_ok
    s_sleep 2
    s_sub_u32 s60, s60, 1
    s_cbranch_scc0 Lshs_10020
Lshs_10020_ok:
    ds_read_b128 v[48:51], v0 offset:0
    ds_read_b128 v[52:55], v0 offset:1024
    ds_read_b128 v[56:59], v0 offset:2048
    ds_read_b128 v[60:63], v0 offset:3072
    ds_read_b128 v[64:67], v0 offset:4096
    ds_read_b128 v[68:71], v0 offset:5120
    ds_read_b128 v[72:75], v0 offset:6144
    ds_read_b128 v[76:79], v0 offset:7168
    ds_read_b128 v[80:83], v0 offset:8192
    ds_read_b128 v[84:87], v0 offset:9216
    s_waitcnt lgkmcnt(5)
    v_mfma_f32_16x16x32_bf16 v[8:11], v[48:51], v[136:139], v[8:11]
    v_mfma_f32_16x16x32_bf16 v[12:15], v[52:55], v[136:139], v[12:15]
    v_mfma_f32_16x16x32_bf16 v[16:19], v[56:59], v[136:139], v[16:19]
    v_mfma_f32_16x16x32_bf16 v[20:23], v[60:63], v[136:139], v[20:23]
    v_mfma_f32_16x16x32_bf16 v[24:27], v[64:67], v[136:139], v[24:27]
    s_add_u32 m0, s47, 40960
    s_add_u32 s55, s49, 122880
    buffer_load_dwordx4 v2, s[8:11], s55 offen lds
    s_add_u32 m0, s47, 41984
    s_add_u32 s55, s49, 123904
    buffer_load_dwordx4 v2, s[8:11], s55 offen lds
    s_add_u32 m0, s47, 43008
    s_add_u32 s55, s49, 124928
    buffer_load_dwordx4 v2, s[8:11], s55 offen lds
    ds_read_b128 v[48:51], v0 offset:10240
    ds_read_b128 v[52:55], v0 offset:11264
    ds_read_b128 v[56:59], v0 offset:12288
    ds_read_b128 v[60:63], v0 offset:13312
    ds_read_b128 v[64:67], v0 offset:14336
    s_waitcnt lgkmcnt(5)
    v_mfma_f32_16x16x32_bf16 v[8:11], v[68:71], v[140:143], v[8:11]
    v_mfma_f32_16x16x32_bf16 v[12:15], v[72:75], v[140:143], v[12:15]
    v_mfma_f32_16x16x32_bf16 v[16:19], v[76:79], v[140:143], v[16:19]
    v_mfma_f32_16x16x32_bf16 v[20:23], v[80:83], v[140:143], v[20:23]
    v_mfma_f32_16x16x32_bf16 v[24:27], v[84:87], v[140:143], v[24:27]
    s_add_u32 m0, s47, 44032
    s_add_u32 s55, s49, 125952
    buffer_load_dwordx4 v2, s[8:11], s55 offen lds
    s_add_u32 m0, s47, 45056
    s_add_u32 s55, s49, 126976
    buffer_load_dwordx4 v2, s[8:11], s55 offen lds
    s_add_u32 s55, s51, 24576
    buffer_load_dwordx4 v[120:123], v2, s[8:11], s55 offen
    ds_read_b128 v[68:71], v0 offset:15360
    ds_read_b128 v[72:75], v0 offset:16384
    ds_read_b128 v[76:79], v0 offset:17408
    ds_read_b128 v[80:83], v0 offset:18432
    ds_read_b128 v[84:87], v0 offset:19456
    s_waitcnt lgkmcnt(5)
    v_mfma_f32_16x16x32_bf16 v[8:11], v[48:51], v[144:147], v[8:11]
    v_mfma_f32_16x16x32_bf16 v[12:15], v[52:55], v[144:147], v[12:15]
    v_mfma_f32_16x16x32_bf16 v[16:19], v[56:59], v[144:147], v[16:19]
    v_mfma_f32_16x16x32_bf16 v[20:23], v[60:63], v[144:147], v[20:23]
    v_mfma_f32_16x16x32_bf16 v[24:27], v[64:67], v[144:147], v[24:27]
    s_add_u32 s55, s51, 25600
    buffer_load_dwordx4 v[124:127], v2, s[8:11], s55 offen
    s_add_u32 s55, s51, 26624
    buffer_load_dwordx4 v[128:131], v2, s[8:11], s55 offen
    s_add_u32 s55, s51, 27648
    buffer_load_dwordx4 v[132:135], v2, s[8:11], s55 offen
    s_waitcnt lgkmcnt(0)
    v_mfma_f32_16x16x32_bf16 v[8:11], v[68:71], v[148:151], v[8:11]
    v_mfma_f32_16x16x32_bf16 v[12:15], v[72:75], v[148:151], v[12:15]
    v_mfma_f32_16x16x32_bf16 v[16:19], v[76:79], v[148:151], v[16:19]
    v_mfma_f32_16x16x32_bf16 v[20:23], v[80:83], v[148:151], v[20:23]
    v_mfma_f32_16x16x32_bf16 v[24:27], v[84:87], v[148:151], v[24:27]
    s_waitcnt vmcnt(18) lgkmcnt(0)
    v_mov_b32 v6, 5
    ds_write_b32 v5, v6
    s_mov_b32 s60, 0x40000
Lshs_10021:
    ds_read_b32 v7, v4
    s_waitcnt lgkmcnt(0)
    v_cmp_le_u32 vcc, 5, v7
    s_cmp_eq_u64 vcc, exec
    s_cbranch_scc1 Lshs_10021_ok
    s_sleep 2
    s_sub_u32 s60, s60, 1
    s_cbranch_scc0 Lshs_10021
Lshs_10021_ok:
    ds_read_b128 v[48:51], v3 offset:0
    ds_read_b128 v[52:55], v3 offset:1024
    ds_read_b128 v[56:59], v3 offset:2048
    ds_read_b128 v[60:63], v3 offset:3072
    ds_read_b128 v[64:67], v3 offset:4096
    ds_read_b128 v[68:71], v3 offset:5120
    ds_read_b128 v[72:75], v3 offset:6144
    ds_read_b128 v[76:79], v3 offset:7168
    ds_read_b128 v[80:83], v3 offset:8192
    ds_read_b128 v[84:87], v3 offset:9216
    s_waitcnt lgkmcnt(5)
    v_mfma_f32_16x16x32_bf16 v[8:11], v[48:51], v[88:91], v[8:11]
    v_mfma_f32_16x16x32_bf16 v[12:15], v[52:55], v[88:91], v[12:15]
    v_mfma_f32_16x16x32_bf16 v[16:19], v[56:59], v[88:91], v[16:19]
    v_mfma_f32_16x16x32_bf16 v[20:23], v[60:63], v[88:91], v[20:23]
    v_mfma_f32_16x16x32_bf16 v[24:27], v[64:67], v[88:91], v[24:27]
    s_add_u32 m0, s47, 61440
    s_add_u32 s55, s49, 143360
    buffer_load_dwordx4 v2, s[8:11], s55 offen lds
    s_add_u32 m0, s47, 62464
    s_add_u32 s55, s49, 144384
    buffer_load_dwordx4 v2, s[8:11], s55 offen lds
    s_add_u32 m0, s47, 63488
    s_add_u32 s55, s49, 145408
    buffer_load_dwordx4 v2, s[8:11], s55 offen lds
    ds_read_b128 v[48:51], v3 offset:10240
    ds_read_b128 v[52:55], v3 offset:11264
    ds_read_b128 v[56:59], v3 offset:12288
    ds_read_b128 v[60:63], v3 offset:13312
    ds_read_b128 v[64:67], v3 offset:14336
    s_waitcnt lgkmcnt(5)
    v_mfma_f32_16x16x32_bf16 v[8:11], v[68:71], v[92:95], v[8:11]
    v_mfma_f32_16x16x32_bf16 v[12:15], v[72:75], v[92:95], v[12:15]
    v_mfma_f32_16x16x32_bf16 v[16:19], v[76:79], v[92:95], v[16:19]
    v_mfma_f32_16x16x32_bf16 v[20:23], v[80:83], v[92:95], v[20:23]
    v_mfma_f32_16x16x32_bf16 v[24:27], v[84:87], v[92:95], v[24:27]
    s_add_u32 m0, s47, 64512
    s_add_u32 s55, s49, 146432
    buffer_load_dwordx4 v2, s[8:11], s55 offen lds
    s_add_u32 m0, s47, 65536
    s_add_u32 s55, s49, 147456
    buffer_load_dwordx4 v2, s[8:11], s55 offen lds
    s_add_u32 s55, s51, 28672
    buffer_load_dwordx4 v[136:139], v2, s[8:11], s55 offen
    ds_read_b128 v[68:71], v3 offset:15360
    ds_read_b128 v[72:75], v3 offset:16384
    ds_read_b128 v[76:79], v3 offset:17408
    ds_read_b128 v[80:83], v3 offset:18432
    ds_read_b128 v[84:87], v3 offset:19456
    s_waitcnt lgkmcnt(5)
    v_mfma_f32_16x16x32_bf16 v[8:11], v[48:51], v[96:99], v[8:11]
    v_mfma_f32_16x16x32_bf16 v[12:15], v[52:55], v[96:99], v[12:15]
    v_mfma_f32_16x16x32_bf16 v[16:19], v[56:59], v[96:99], v[16:19]
    v_mfma_f32_16x16x32_bf16 v[20:23], v[60:63], v[96:99], v[20:23]
    v_mfma_f32_16x16x32_bf16 v[24:27], v[64:67], v[96:99], v[24:27]
    s_add_u32 s55, s51, 29696
    buffer_load_dwordx4 v[140:143], v2, s[8:11], s55 offen
    s_add_u32 s55, s51, 30720
    buffer_load_dwordx4 v[144:147], v2, s[8:11], s55 offen
    s_add_u32 s55, s51, 31744
    buffer_load_dwordx4 v[148:151], v2, s[8:11], s55 offen
    s_waitcnt lgkmcnt(0)
    v_mfma_f32_16x16x32_bf16 v[8:11], v[68:71], v[100:103], v[8:11]
    v_mfma_f32_16x16x32_bf16 v[12:15], v[72:75], v[100:103], v[12:15]
    v_mfma_f32_16x16x32_bf16 v[16:19], v[76:79], v[100:103], v[16:19]
    v_mfma_f32_16x16x32_bf16 v[20:23], v[80:83], v[100:103], v[20:23]
    v_mfma_f32_16x16x32_bf16 v[24:27], v[84:87], v[100:103], v[24:27]
    s_waitcnt vmcnt(18) lgkmcnt(0)
    v_mov_b32 v6, 6
    ds_write_b32 v5, v6
    s_mov_b32 s60, 0x40000
Lshs_10022:
    ds_read_b32 v7, v4
    s_waitcnt lgkmcnt(0)
    v_cmp_le_u32 vcc, 6, v7
    s_cmp_eq_u64 vcc, exec
    s_cbranch_scc1 Lshs_10022_ok
    s_sleep 2
    s_sub_u32 s60, s60, 1
    s_cbranch_scc0 Lshs_10022
Lshs_10022_ok:
    ds_read_b128 v[48:51], v3 offset:20480
    ds_read_b128 v[52:55], v3 offset:21504
    ds_read_b128 v[56:59], v3 offset:22528
    ds_read_b128 v[60:63], v3 offset:23552
    ds_read_b128 v[64:67], v3 offset:24576
    ds_read_b128 v[68:71], v3 offset:25600
    ds_read_b128 v[72:75], v3 offset:26624
    ds_read_b128 v[76:79], v3 offset:27648
    ds_read_b128 v[80:83], v3 offset:28672
    ds_read_b128 v[84:87], v3 offset:29696
    s_waitcnt lgkmcnt(5)
    v_mfma_f32_16x16x32_bf16 v[8:11], v[48:51], v[104:107], v[8:11]
    v_mfma_f32_16x16x32_bf16 v[12:15], v[52:55], v[104:107], v[12:15]
    v_mfma_f32_16x16x32_bf16 v[16:19], v[56:59], v[104:107], v[16:19]
    v_mfma_f32_16x16x32_bf16 v[20:23], v[60:63], v[104:107], v[20:23]
    v_mfma_f32_16x16x32_bf16 v[24:27], v[64:67], v[104:107], v[24:27]
    s_add_u32 m0, s47, 0
    s_add_u32 s55, s49, 163840
    buffer_load_dwordx4 v2, s[8:11], s55 offen lds
    s_add_u32 m0, s47, 1024
    s_add_u32 s55, s49, 164864
    buffer_load_dwordx4 v2, s[8:11], s55 offen lds
    s_add_u32 m0, s47, 2048
    s_add_u32 s55, s49, 165888
    buffer_load_dwordx4 v2, s[8:11], s55 offen lds
    ds_read_b128 v[48:51], v3 offset:30720
    ds_read_b128 v[52:55], v3 offset:31744
    ds_read_b128 v[56:59], v3 offset:32768
    ds_read_b128 v[60:63], v3 offset:33792
    ds_read_b128 v[64:67], v3 offset:34816
    s_waitcnt lgkmcnt(5)
    v_mfma_f32_16x16x32_bf16 v[8:11], v[68:71], v[108:111], v[8:11]
    v_mfma_f32_16x16x32_bf16 v[12:15], v[72:75], v[108:111], v[12:15]
    v_mfma_f32_16x16x32_bf16 v[16:19], v[76:79], v[108:111], v[16:19]
    v_mfma_f32_16x16x32_bf16 v[20:23], v[80:83], v[108:111], v[20:23]
    v_mfma_f32_16x16x32_bf16 v[24:27], v[84:87], v[108:111], v[24:27]
    s_add_u32 m0, s47, 3072
    s_add_u32 s55, s49, 166912
    buffer_load_dwordx4 v2, s[8:11], s55 offen lds
    s_add_u32 m0, s47, 4096
    s_add_u32 s55, s49, 167936
    buffer_load_dwordx4 v2, s[8:11], s55 offen lds
    s_add_u32 s55, s51, 32768
    buffer_load_dwordx4 v[88:91], v2, s[8:11], s55 offen
    ds_read_b128 v[68:71], v3 offset:35840
    ds_read_b128 v[72:75], v3 offset:36864
    ds_read_b128 v[76:79], v3 offset:37888
    ds_read_b128 v[80:83], v3 offset:38912
    ds_read_b128 v[84:87], v3 offset:39936
    s_waitcnt lgkmcnt(5)
    v_mfma_f32_16x16x32_bf16 v[8:11], v[48:51], v[112:115], v[8:11]
    v_mfma_f32_16x16x32_bf16 v[12:15], v[52:55], v[112:115], v[12:15]
    v_mfma_f32_16x16x32_bf16 v[16:19], v[56:59], v[112:115], v[16:19]
    v_mfma_f32_16x16x32_bf16 v[20:23], v[60:63], v[112:115], v[20:23]
    v_mfma_f32_16x16x32_bf16 v[24:27], v[64:67], v[112:115], v[24:27]
    s_add_u32 s55, s51, 33792
    buffer_load_dwordx4 v[92:95], v2, s[8:11], s55 offen
    s_add_u32 s55, s51, 34816
    buffer_load_dwordx4 v[96:99], v2, s[8:11], s55 offen
    s_add_u32 s55, s51, 35840
    buffer_load_dwordx4 v[100:103], v2, s[8:11], s55 offen
    s_waitcnt lgkmcnt(0)
    v_mfma_f32_16x16x32_bf16 v[8:11], v[68:71], v[116:119], v[8:11]
    v_mfma_f32_16x16x32_bf16 v[12:15], v[72:75], v[116:119], v[12:15]
    v_mfma_f32_16x16x32_bf16 v[16:19], v[76:79], v[116:119], v[16:19]
    v_mfma_f32_16x16x32_bf16 v[20:23], v[80:83], v[116:119], v[20:23]
    v_mfma_f32_16x16x32_bf16 v[24:27], v[84:87], v[116:119], v[24:27]
    s_waitcnt vmcnt(18) lgkmcnt(0)
    v_mov_b32 v6, 7
    ds_write_b32 v5, v6
    s_mov_b32 s60, 0x40000
Lshs_10023:
    ds_read_b32 v7, v4
    s_waitcnt lgkmcnt(0)
    v_cmp_le_u32 vcc, 7, v7
    s_cmp_eq_u64 vcc, exec
    s_cbranch_scc1 Lshs_10023_ok
    s_sleep 2
    s_sub_u32 s60, s60, 1
    s_cbranch_scc0 Lshs_10023
Lshs_10023_ok:
    ds_read_b128 v[48:51], v3 offset:40960
    ds_read_b128 v[52:55], v3 offset:41984
    ds_read_b128 v[56:59], v3 offset:43008
    ds_read_b128 v[60:63], v3 offset:44032
    ds_read_b128 v[64:67], v3 offset:45056
    ds_read_b128 v[68:71], v3 offset:46080
    ds_read_b128 v[72:75], v3 offset:47104
    ds_read_b128 v[76:79], v3 offset:48128
    ds_read_b128 v[80:83], v3 offset:49152
    ds_read_b128 v[84:87], v3 offset:50176
    s_waitcnt lgkmcnt(5)
    v_mfma_f32_16x16x32_bf16 v[8:11], v[48:51], v[120:123], v[8:11]
    v_mfma_f32_16x16x32_bf16 v[12:15], v[52:55], v[120:123], v[12:15]
    v_mfma_f32_16x16x32_bf16 v[16:19], v[56:59], v[120:123], v[16:19]
    v_mfma_f32_16x16x32_bf16 v[20:23], v[60:63], v[120:123], v[20:23]
    v_mfma_f32_16x16x32_bf16 v[24:27], v[64:67], v[120:123], v[24:27]
    s_add_u32 m0, s47, 20480
    s_add_u32 s55, s49, 184320
    buffer_load_dwordx4 v2, s[8:11], s55 offen lds
    s_add_u32 m0, s47, 21504
    s_add_u32 s55, s49, 185344
    buffer_load_dwordx4 v2, s[8:11], s55 offen lds
    s_add_u32 m0, s47, 22528
    s_add_u32 s55, s49, 186368
    buffer_load_dwordx4 v2, s[8:11], s55 offen lds
    ds_read_b128 v[48:51], v3 offset:51200
    ds_read_b128 v[52:55], v3 offset:52224
    ds_read_b128 v[56:59], v3 offset:53248
    ds_read_b128 v[60:63], v3 offset:54272
    ds_read_b128 v[64:67], v3 offset:55296
    s_waitcnt lgkmcnt(5)
    v_mfma_f32_16x16x32_bf16 v[8:11], v[68:71], v[124:127], v[8:11]
    v_mfma_f32_16x16x32_bf16 v[12:15], v[72:75], v[124:127], v[12:15]
    v_mfma_f32_16x16x32_bf16 v[16:19], v[76:79], v[124:127], v[16:19]
    v_mfma_f32_16x16x32_bf16 v[20:23], v[80:83], v[124:127], v[20:23]
    v_mfma_f32_16x16x32_bf16 v[24:27], v[84:87], v[124:127], v[24:27]
    s_add_u32 m0, s47, 23552
    s_add_u32 s55, s49, 187392
    buffer_load_dwordx4 v2, s[8:11], s55 offen lds
    s_add_u32 m0, s47, 24576
    s_add_u32 s55, s49, 188416
    buffer_load_dwordx4 v2, s[8:11], s55 offen lds
    s_add_u32 s55, s51, 36864
    buffer_load_dwordx4 v[104:107], v2, s[8:11], s55 offen
    ds_read_b128 v[68:71], v3 offset:56320
    ds_read_b128 v[72:75], v3 offset:57344
    ds_read_b128 v[76:79], v3 offset:58368
    ds_read_b128 v[80:83], v3 offset:59392
    ds_read_b128 v[84:87], v3 offset:60416
    s_waitcnt lgkmcnt(5)
    v_mfma_f32_16x16x32_bf16 v[8:11], v[48:51], v[128:131], v[8:11]
    v_mfma_f32_16x16x32_bf16 v[12:15], v[52:55], v[128:131], v[12:15]
    v_mfma_f32_16x16x32_bf16 v[16:19], v[56:59], v[128:131], v[16:19]
    v_mfma_f32_16x16x32_bf16 v[20:23], v[60:63], v[128:131], v[20:23]
    v_mfma_f32_16x16x32_bf16 v[24:27], v[64:67], v[128:131], v[24:27]
    s_add_u32 s55, s51, 37888
    buffer_load_dwordx4 v[108:111], v2, s[8:11], s55 offen
    s_add_u32 s55, s51, 38912
    buffer_load_dwordx4 v[112:115], v2, s[8:11], s55 offen
    s_add_u32 s55, s51, 39936
    buffer_load_dwordx4 v[116:119], v2, s[8:11], s55 offen
    s_waitcnt lgkmcnt(0)
    v_mfma_f32_16x16x32_bf16 v[8:11], v[68:71], v[132:135], v[8:11]
    v_mfma_f32_16x16x32_bf16 v[12:15], v[72:75], v[132:135], v[12:15]
    v_mfma_f32_16x16x32_bf16 v[16:19], v[76:79], v[132:135], v[16:19]
    v_mfma_f32_16x16x32_bf16 v[20:23], v[80:83], v[132:135], v[20:23]
    v_mfma_f32_16x16x32_bf16 v[24:27], v[84:87], v[132:135], v[24:27]
    s_waitcnt vmcnt(18) lgkmcnt(0)
    v_mov_b32 v6, 8
    ds_write_b32 v5, v6
    s_mov_b32 s60, 0x40000
Lshs_10024:
    ds_read_b32 v7, v4
    s_waitcnt lgkmcnt(0)
    v_cmp_le_u32 vcc, 8, v7
    s_cmp_eq_u64 vcc, exec
    s_cbranch_scc1 Lshs_10024_ok
    s_sleep 2
    s_sub_u32 s60, s60, 1
    s_cbranch_scc0 Lshs_10024
Lshs_10024_ok:
    ds_read_b128 v[48:51], v0 offset:0
    ds_read_b128 v[52:55], v0 offset:1024
    ds_read_b128 v[56:59], v0 offset:2048
    ds_read_b128 v[60:63], v0 offset:3072
    ds_read_b128 v[64:67], v0 offset:4096
    ds_read_b128 v[68:71], v0 offset:5120
    ds_read_b128 v[72:75], v0 offset:6144
    ds_read_b128 v[76:79], v0 offset:7168
    ds_read_b128 v[80:83], v0 offset:8192
    ds_read_b128 v[84:87], v0 offset:9216
    s_waitcnt lgkmcnt(5)
    v_mfma_f32_16x16x32_bf16 v[8:11], v[48:51], v[136:139], v[8:11]
    v_mfma_f32_16x16x32_bf16 v[12:15], v[52:55], v[136:139], v[12:15]
    v_mfma_f32_16x16x32_bf16 v[16:19], v[56:59], v[136:139], v[16:19]
    v_mfma_f32_16x16x32_bf16 v[20:23], v[60:63], v[136:139], v[20:23]
    v_mfma_f32_16x16x32_bf16 v[24:27], v[64:67], v[136:139], v[24:27]
    s_add_u32 m0, s47, 40960
    s_add_u32 s55, s49, 204800
    buffer_load_dwordx4 v2, s[8:11], s55 offen lds
    s_add_u32 m0, s47, 41984
    s_add_u32 s55, s49, 205824
    buffer_load_dwordx4 v2, s[8:11], s55 offen lds
    s_add_u32 m0, s47, 43008
    s_add_u32 s55, s49, 206848
    buffer_load_dwordx4 v2, s[8:11], s55 offen lds
    ds_read_b128 v[48:51], v0 offset:10240
    ds_read_b128 v[52:55], v0 offset:11264
    ds_read_b128 v[56:59], v0 offset:12288
    ds_read_b128 v[60:63], v0 offset:13312
    ds_read_b128 v[64:67], v0 offset:14336
    s_waitcnt lgkmcnt(5)
    v_mfma_f32_16x16x32_bf16 v[8:11], v[68:71], v[140:143], v[8:11]
    v_mfma_f32_16x16x32_bf16 v[12:15], v[72:75], v[140:143], v[12:15]
    v_mfma_f32_16x16x32_bf16 v[16:19], v[76:79], v[140:143], v[16:19]
    v_mfma_f32_16x16x32_bf16 v[20:23], v[80:83], v[140:143], v[20:23]
    v_mfma_f32_16x16x32_bf16 v[24:27], v[84:87], v[140:143], v[24:27]
    s_add_u32 m0, s47, 44032
    s_add_u32 s55, s49, 207872
    buffer_load_dwordx4 v2, s[8:11], s55 offen lds
    s_add_u32 m0, s47, 45056
    s_add_u32 s55, s49, 208896
    buffer_load_dwordx4 v2, s[8:11], s55 offen lds
    s_add_u32 s55, s51, 40960
    buffer_load_dwordx4 v[120:123], v2, s[8:11], s55 offen
    ds_read_b128 v[68:71], v0 offset:15360
    ds_read_b128 v[72:75], v0 offset:16384
    ds_read_b128 v[76:79], v0 offset:17408
    ds_read_b128 v[80:83], v0 offset:18432
    ds_read_b128 v[84:87], v0 offset:19456
    s_waitcnt lgkmcnt(5)
    v_mfma_f32_16x16x32_bf16 v[8:11], v[48:51], v[144:147], v[8:11]
    v_mfma_f32_16x16x32_bf16 v[12:15], v[52:55], v[144:147], v[12:15]
    v_mfma_f32_16x16x32_bf16 v[16:19], v[56:59], v[144:147], v[16:19]
    v_mfma_f32_16x16x32_bf16 v[20:23], v[60:63], v[144:147], v[20:23]
    v_mfma_f32_16x16x32_bf16 v[24:27], v[64:67], v[144:147], v[24:27]
    s_add_u32 s55, s51, 41984
    buffer_load_dwordx4 v[124:127], v2, s[8:11], s55 offen
    s_add_u32 s55, s51, 43008
    buffer_load_dwordx4 v[128:131], v2, s[8:11], s55 offen
    s_add_u32 s55, s51, 44032
    buffer_load_dwordx4 v[132:135], v2, s[8:11], s55 offen
    s_waitcnt lgkmcnt(0)
    v_mfma_f32_16x16x32_bf16 v[8:11], v[68:71], v[148:151], v[8:11]
    v_mfma_f32_16x16x32_bf16 v[12:15], v[72:75], v[148:151], v[12:15]
    v_mfma_f32_16x16x32_bf16 v[16:19], v[76:79], v[148:151], v[16:19]
    v_mfma_f32_16x16x32_bf16 v[20:23], v[80:83], v[148:151], v[20:23]
    v_mfma_f32_16x16x32_bf16 v[24:27], v[84:87], v[148:151], v[24:27]
    s_waitcnt vmcnt(18) lgkmcnt(0)
    v_mov_b32 v6, 9
    ds_write_b32 v5, v6
    s_mov_b32 s60, 0x40000
Lshs_10025:
    ds_read_b32 v7, v4
    s_waitcnt lgkmcnt(0)
    v_cmp_le_u32 vcc, 9, v7
    s_cmp_eq_u64 vcc, exec
    s_cbranch_scc1 Lshs_10025_ok
    s_sleep 2
    s_sub_u32 s60, s60, 1
    s_cbranch_scc0 Lshs_10025
Lshs_10025_ok:
    ds_read_b128 v[48:51], v3 offset:0
    ds_read_b128 v[52:55], v3 offset:1024
    ds_read_b128 v[56:59], v3 offset:2048
    ds_read_b128 v[60:63], v3 offset:3072
    ds_read_b128 v[64:67], v3 offset:4096
    ds_read_b128 v[68:71], v3 offset:5120
    ds_read_b128 v[72:75], v3 offset:6144
    ds_read_b128 v[76:79], v3 offset:7168
    ds_read_b128 v[80:83], v3 offset:8192
    ds_read_b128 v[84:87], v3 offset:9216
    s_waitcnt lgkmcnt(5)
    v_mfma_f32_16x16x32_bf16 v[8:11], v[48:51], v[88:91], v[8:11]
    v_mfma_f32_16x16x32_bf16 v[12:15], v[52:55], v[88:91], v[12:15]
    v_mfma_f32_16x16x32_bf16 v[16:19], v[56:59], v[88:91], v[16:19]
    v_mfma_f32_16x16x32_bf16 v[20:23], v[60:63], v[88:91], v[20:23]
    v_mfma_f32_16x16x32_bf16 v[24:27], v[64:67], v[88:91], v[24:27]
    s_add_u32 m0, s47, 61440
    s_add_u32 s55, s49, 225280
    buffer_load_dwordx4 v2, s[8:11], s55 offen lds
    s_add_u32 m0, s47, 62464
    s_add_u32 s55, s49, 226304
    buffer_load_dwordx4 v2, s[8:11], s55 offen lds
    s_add_u32 m0, s47, 63488
    s_add_u32 s55, s49, 227328
    buffer_load_dwordx4 v2, s[8:11], s55 offen lds
    ds_read_b128 v[48:51], v3 offset:10240
    ds_read_b128 v[52:55], v3 offset:11264
    ds_read_b128 v[56:59], v3 offset:12288
    ds_read_b128 v[60:63], v3 offset:13312
    ds_read_b128 v[64:67], v3 offset:14336
    s_waitcnt lgkmcnt(5)
    v_mfma_f32_16x16x32_bf16 v[8:11], v[68:71], v[92:95], v[8:11]
    v_mfma_f32_16x16x32_bf16 v[12:15], v[72:75], v[92:95], v[12:15]
    v_mfma_f32_16x16x32_bf16 v[16:19], v[76:79], v[92:95], v[16:19]
    v_mfma_f32_16x16x32_bf16 v[20:23], v[80:83], v[92:95], v[20:23]
    v_mfma_f32_16x16x32_bf16 v[24:27], v[84:87], v[92:95], v[24:27]
    s_add_u32 m0, s47, 64512
    s_add_u32 s55, s49, 228352
    buffer_load_dwordx4 v2, s[8:11], s55 offen lds
    s_add_u32 m0, s47, 65536
    s_add_u32 s55, s49, 229376
    buffer_load_dwordx4 v2, s[8:11], s55 offen lds
    s_add_u32 s55, s51, 45056
    buffer_load_dwordx4 v[136:139], v2, s[8:11], s55 offen
    ds_read_b128 v[68:71], v3 offset:15360
    ds_read_b128 v[72:75], v3 offset:16384
    ds_read_b128 v[76:79], v3 offset:17408
    ds_read_b128 v[80:83], v3 offset:18432
    ds_read_b128 v[84:87], v3 offset:19456
    s_waitcnt lgkmcnt(5)
    v_mfma_f32_16x16x32_bf16 v[8:11], v[48:51], v[96:99], v[8:11]
    v_mfma_f32_16x16x32_bf16 v[12:15], v[52:55], v[96:99], v[12:15]
    v_mfma_f32_16x16x32_bf16 v[16:19], v[56:59], v[96:99], v[16:19]
    v_mfma_f32_16x16x32_bf16 v[20:23], v[60:63], v[96:99], v[20:23]
    v_mfma_f32_16x16x32_bf16 v[24:27], v[64:67], v[96:99], v[24:27]
    s_add_u32 s55, s51, 46080
    buffer_load_dwordx4 v[140:143], v2, s[8:11], s55 offen
    s_add_u32 s55, s51, 47104
    buffer_load_dwordx4 v[144:147], v2, s[8:11], s55 offen
    s_add_u32 s55, s51, 48128
    buffer_load_dwordx4 v[148:151], v2, s[8:11], s55 offen
    s_waitcnt lgkmcnt(0)
    v_mfma_f32_16x16x32_bf16 v[8:11], v[68:71], v[100:103], v[8:11]
    v_mfma_f32_16x16x32_bf16 v[12:15], v[72:75], v[100:103], v[12:15]
    v_mfma_f32_16x16x32_bf16 v[16:19], v[76:79], v[100:103], v[16:19]
    v_mfma_f32_16x16x32_bf16 v[20:23], v[80:83], v[100:103], v[20:23]
    v_mfma_f32_16x16x32_bf16 v[24:27], v[84:87], v[100:103], v[24:27]
    s_waitcnt vmcnt(18) lgkmcnt(0)
    v_mov_b32 v6, 10
    ds_write_b32 v5, v6
    s_mov_b32 s60, 0x40000
Lshs_10026:
    ds_read_b32 v7, v4
    s_waitcnt lgkmcnt(0)
    v_cmp_le_u32 vcc, 10, v7
    s_cmp_eq_u64 vcc, exec
    s_cbranch_scc1 Lshs_10026_ok
    s_sleep 2
    s_sub_u32 s60, s60, 1
    s_cbranch_scc0 Lshs_10026
Lshs_10026_ok:
    ds_read_b128 v[48:51], v3 offset:20480
    ds_read_b128 v[52:55], v3 offset:21504
    ds_read_b128 v[56:59], v3 offset:22528
    ds_read_b128 v[60:63], v3 offset:23552
    ds_read_b128 v[64:67], v3 offset:24576
    ds_read_b128 v[68:71], v3 offset:25600
    ds_read_b128 v[72:75], v3 offset:26624
    ds_read_b128 v[76:79], v3 offset:27648
    ds_read_b128 v[80:83], v3 offset:28672
    ds_read_b128 v[84:87], v3 offset:29696
    s_waitcnt lgkmcnt(5)
    v_mfma_f32_16x16x32_bf16 v[8:11], v[48:51], v[104:107], v[8:11]
    v_mfma_f32_16x16x32_bf16 v[12:15], v[52:55], v[104:107], v[12:15]
    v_mfma_f32_16x16x32_bf16 v[16:19], v[56:59], v[104:107], v[16:19]
    v_mfma_f32_16x16x32_bf16 v[20:23], v[60:63], v[104:107], v[20:23]
    v_mfma_f32_16x16x32_bf16 v[24:27], v[64:67], v[104:107], v[24:27]
    s_add_u32 m0, s47, 0
    s_add_u32 s55, s49, 245760
    buffer_load_dwordx4 v2, s[8:11], s55 offen lds
    s_add_u32 m0, s47, 1024
    s_add_u32 s55, s49, 246784
    buffer_load_dwordx4 v2, s[8:11], s55 offen lds
    ds_read_b128 v[48:51], v3 offset:30720
    ds_read_b128 v[52:55], v3 offset:31744
    ds_read_b128 v[56:59], v3 offset:32768
    ds_read_b128 v[60:63], v3 offset:33792
    ds_read_b128 v[64:67], v3 offset:34816
    s_waitcnt lgkmcnt(5)
    v_mfma_f32_16x16x32_bf16 v[8:11], v[68:71], v[108:111], v[8:11]
    v_mfma_f32_16x16x32_bf16 v[12:15], v[72:75], v[108:111], v[12:15]
    v_mfma_f32_16x16x32_bf16 v[16:19], v[76:79], v[108:111], v[16:19]
    v_mfma_f32_16x16x32_bf16 v[20:23], v[80:83], v[108:111], v[20:23]
    v_mfma_f32_16x16x32_bf16 v[24:27], v[84:87], v[108:111], v[24:27]
    s_add_u32 m0, s47, 2048
    s_add_u32 s55, s49, 247808
    buffer_load_dwordx4 v2, s[8:11], s55 offen lds
    s_add_u32 m0, s47, 3072
    s_add_u32 s55, s49, 248832
    buffer_load_dwordx4 v2, s[8:11], s55 offen lds
    ds_read_b128 v[68:71], v3 offset:35840
    ds_read_b128 v[72:75], v3 offset:36864
    ds_read_b128 v[76:79], v3 offset:37888
    ds_read_b128 v[80:83], v3 offset:38912
    ds_read_b128 v[84:87], v3 offset:39936
    s_waitcnt lgkmcnt(5)
    v_mfma_f32_16x16x32_bf16 v[8:11], v[48:51], v[112:115], v[8:11]
    v_mfma_f32_16x16x32_bf16 v[12:15], v[52:55], v[112:115], v[12:15]
    v_mfma_f32_16x16x32_bf16 v[16:19], v[56:59], v[112:115], v[16:19]
    v_mfma_f32_16x16x32_bf16 v[20:23], v[60:63], v[112:115], v[20:23]
    v_mfma_f32_16x16x32_bf16 v[24:27], v[64:67], v[112:115], v[24:27]
    s_add_u32 m0, s47, 4096
    s_add_u32 s55, s49, 249856
    buffer_load_dwordx4 v2, s[8:11], s55 offen lds
    s_waitcnt lgkmcnt(0)
    v_mfma_f32_16x16x32_bf16 v[8:11], v[68:71], v[116:119], v[8:11]
    v_mfma_f32_16x16x32_bf16 v[12:15], v[72:75], v[116:119], v[12:15]
    v_mfma_f32_16x16x32_bf16 v[16:19], v[76:79], v[116:119], v[16:19]
    v_mfma_f32_16x16x32_bf16 v[20:23], v[80:83], v[116:119], v[20:23]
    v_mfma_f32_16x16x32_bf16 v[24:27], v[84:87], v[116:119], v[24:27]
    s_waitcnt vmcnt(14) lgkmcnt(0)
    v_mov_b32 v6, 11
    ds_write_b32 v5, v6
    s_mov_b32 s60, 0x40000
Lshs_10027:
    ds_read_b32 v7, v4
    s_waitcnt lgkmcnt(0)
    v_cmp_le_u32 vcc, 11, v7
    s_cmp_eq_u64 vcc, exec
    s_cbranch_scc1 Lshs_10027_ok
    s_sleep 2
    s_sub_u32 s60, s60, 1
    s_cbranch_scc0 Lshs_10027
Lshs_10027_ok:
    ds_read_b128 v[48:51], v3 offset:40960
    ds_read_b128 v[52:55], v3 offset:41984
    ds_read_b128 v[56:59], v3 offset:43008
    ds_read_b128 v[60:63], v3 offset:44032
    ds_read_b128 v[64:67], v3 offset:45056
    ds_read_b128 v[68:71], v3 offset:46080
    ds_read_b128 v[72:75], v3 offset:47104
    ds_read_b128 v[76:79], v3 offset:48128
    ds_read_b128 v[80:83], v3 offset:49152
    ds_read_b128 v[84:87], v3 offset:50176
    s_waitcnt lgkmcnt(5)
    v_mfma_f32_16x16x32_bf16 v[8:11], v[48:51], v[120:123], v[8:11]
    v_mfma_f32_16x16x32_bf16 v[12:15], v[52:55], v[120:123], v[12:15]
    v_mfma_f32_16x16x32_bf16 v[16:19], v[56:59], v[120:123], v[16:19]
    v_mfma_f32_16x16x32_bf16 v[20:23], v[60:63], v[120:123], v[20:23]
    v_mfma_f32_16x16x32_bf16 v[24:27], v[64:67], v[120:123], v[24:27]
    s_add_u32 m0, s47, 20480
    s_add_u32 s55, s49, 266240
    buffer_load_dwordx4 v2, s[8:11], s55 offen lds
    s_add_u32 m0, s47, 21504
    s_add_u32 s55, s49, 267264
    buffer_load_dwordx4 v2, s[8:11], s55 offen lds
    ds_read_b128 v[48:51], v3 offset:51200
    ds_read_b128 v[52:55], v3 offset:52224
    ds_read_b128 v[56:59], v3 offset:53248
    ds_read_b128 v[60:63], v3 offset:54272
    ds_read_b128 v[64:67], v3 offset:55296
    s_waitcnt lgkmcnt(5)
    v_mfma_f32_16x16x32_bf16 v[8:11], v[68:71], v[124:127], v[8:11]
    v_mfma_f32_16x16x32_bf16 v[12:15], v[72:75], v[124:127], v[12:15]
    v_mfma_f32_16x16x32_bf16 v[16:19], v[76:79], v[124:127], v[16:19]
    v_mfma_f32_16x16x32_bf16 v[20:23], v[80:83], v[124:127], v[20:23]
    v_mfma_f32_16x16x32_bf16 v[24:27], v[84:87], v[124:127], v[24:27]
    s_add_u32 m0, s47, 22528
    s_add_u32 s55, s49, 268288
    buffer_load_dwordx4 v2, s[8:11], s55 offen lds
    s_add_u32 m0, s47, 23552
    s_add_u32 s55, s49, 269312
    buffer_load_dwordx4 v2, s[8:11], s55 offen lds
    ds_read_b128 v[68:71], v3 offset:56320
    ds_read_b128 v[72:75], v3 offset:57344
    ds_read_b128 v[76:79], v3 offset:58368
    ds_read_b128 v[80:83], v3 offset:59392
    ds_read_b128 v[84:87], v3 offset:60416
    s_waitcnt lgkmcnt(5)
    v_mfma_f32_16x16x32_bf16 v[8:11], v[48:51], v[128:131], v[8:11]
    v_mfma_f32_16x16x32_bf16 v[12:15], v[52:55], v[128:131], v[12:15]
    v_mfma_f32_16x16x32_bf16 v[16:19], v[56:59], v[128:131], v[16:19]
    v_mfma_f32_16x16x32_bf16 v[20:23], v[60:63], v[128:131], v[20:23]
    v_mfma_f32_16x16x32_bf16 v[24:27], v[64:67], v[128:131], v[24:27]
    s_add_u32 m0, s47, 24576
    s_add_u32 s55, s49, 270336
    buffer_load_dwordx4 v2, s[8:11], s55 offen lds
    s_waitcnt lgkmcnt(0)
    v_mfma_f32_16x16x32_bf16 v[8:11], v[68:71], v[132:135], v[8:11]
    v_mfma_f32_16x16x32_bf16 v[12:15], v[72:75], v[132:135], v[12:15]
    v_mfma_f32_16x16x32_bf16 v[16:19], v[76:79], v[132:135], v[16:19]
    v_mfma_f32_16x16x32_bf16 v[20:23], v[80:83], v[132:135], v[20:23]
    v_mfma_f32_16x16x32_bf16 v[24:27], v[84:87], v[132:135], v[24:27]
    s_waitcnt lgkmcnt(0)
    s_barrier
    s_setprio 3
    s_waitcnt vmcnt(10) lgkmcnt(0)
    s_barrier
    ds_read_b128 v[48:51], v0 offset:0
    ds_read_b128 v[52:55], v0 offset:1024
    ds_read_b128 v[56:59], v0 offset:2048
    ds_read_b128 v[60:63], v0 offset:3072
    ds_read_b128 v[64:67], v0 offset:4096
    ds_read_b128 v[68:71], v0 offset:5120
    ds_read_b128 v[72:75], v0 offset:6144
    ds_read_b128 v[76:79], v0 offset:7168
    ds_read_b128 v[80:83], v0 offset:8192
    ds_read_b128 v[84:87], v0 offset:9216
    s_waitcnt lgkmcnt(5)
    v_mfma_f32_16x16x32_bf16 v[8:11], v[48:51], v[136:139], v[8:11]
    v_mfma_f32_16x16x32_bf16 v[12:15], v[52:55], v[136:139], v[12:15]
    v_mfma_f32_16x16x32_bf16 v[16:19], v[56:59], v[136:139], v[16:19]
    v_mfma_f32_16x16x32_bf16 v[20:23], v[60:63], v[136:139], v[20:23]
    v_mfma_f32_16x16x32_bf16 v[24:27], v[64:67], v[136:139], v[24:27]
    s_add_u32 m0, s47, 40960
    s_add_u32 s55, s49, 286720
    buffer_load_dwordx4 v2, s[8:11], s55 offen lds
    s_add_u32 m0, s47, 41984
    s_add_u32 s55, s49, 287744
    buffer_load_dwordx4 v2, s[8:11], s55 offen lds
    ds_read_b128 v[48:51], v0 offset:10240
    ds_read_b128 v[52:55], v0 offset:11264
    ds_read_b128 v[56:59], v0 offset:12288
    ds_read_b128 v[60:63], v0 offset:13312
    ds_read_b128 v[64:67], v0 offset:14336
    s_waitcnt lgkmcnt(5)
    v_mfma_f32_16x16x32_bf16 v[8:11], v[68:71], v[140:143], v[8:11]
    v_mfma_f32_16x16x32_bf16 v[12:15], v[72:75], v[140:143], v[12:15]
    v_mfma_f32_16x16x32_bf16 v[16:19], v[76:79], v[140:143], v[16:19]
    v_mfma_f32_16x16x32_bf16 v[20:23], v[80:83], v[140:143], v[20:23]
    v_mfma_f32_16x16x32_bf16 v[24:27], v[84:87], v[140:143], v[24:27]
    s_add_u32 m0, s47, 43008
    s_add_u32 s55, s49, 288768
    buffer_load_dwordx4 v2, s[8:11], s55 offen lds
    s_add_u32 m0, s47, 44032
    s_add_u32 s55, s49, 289792
    buffer_load_dwordx4 v2, s[8:11], s55 offen lds
    ds_read_b128 v[68:71], v0 offset:15360
    ds_read_b128 v[72:75], v0 offset:16384
    ds_read_b128 v[76:79], v0 offset:17408
    ds_read_b128 v[80:83], v0 offset:18432
    ds_read_b128 v[84:87], v0 offset:19456
    s_waitcnt lgkmcnt(5)
    v_mfma_f32_16x16x32_bf16 v[8:11], v[48:51], v[144:147], v[8:11]
    v_mfma_f32_16x16x32_bf16 v[12:15], v[52:55], v[144:147], v[12:15]
    v_mfma_f32_16x16x32_bf16 v[16:19], v[56:59], v[144:147], v[16:19]
    v_mfma_f32_16x16x32_bf16 v[20:23], v[60:63], v[144:147], v[20:23]
    v_mfma_f32_16x16x32_bf16 v[24:27], v[64:67], v[144:147], v[24:27]
    s_add_u32 m0, s47, 45056
    s_add_u32 s55, s49, 290816
    buffer_load_dwordx4 v2, s[8:11], s55 offen lds
    s_waitcnt lgkmcnt(0)
    v_mfma_f32_16x16x32_bf16 v[8:11], v[68:71], v[148:151], v[8:11]
    v_mfma_f32_16x16x32_bf16 v[12:15], v[72:75], v[148:151], v[12:15]
    v_mfma_f32_16x16x32_bf16 v[16:19], v[76:79], v[148:151], v[16:19]
    v_mfma_f32_16x16x32_bf16 v[20:23], v[80:83], v[148:151], v[20:23]
    v_mfma_f32_16x16x32_bf16 v[24:27], v[84:87], v[148:151], v[24:27]
    s_cmp_eq_u32 s40, 0
    s_cbranch_scc1 Lsh_poller
    s_sub_u32 s54, s40, 1
    s_mul_i32 s61, s43, 348160
    s_add_u32 s61, s61, 18132992
    s_add_u32 s55, s54, 0
    s_lshl_b32 s55, s55, 10
    s_mov_b32 m0, s55
    s_add_u32 s55, s55, s61
    buffer_load_dwordx4 v2, s[8:11], s55 offen lds
    s_add_u32 s55, s54, 3
    s_lshl_b32 s55, s55, 10
    s_mov_b32 m0, s55
    s_add_u32 s55, s55, s61
    buffer_load_dwordx4 v2, s[8:11], s55 offen lds
    s_add_u32 s55, s54, 6
    s_lshl_b32 s55, s55, 10
    s_mov_b32 m0, s55
    s_add_u32 s55, s55, s61
    buffer_load_dwordx4 v2, s[8:11], s55 offen lds
    s_add_u32 s55, s54, 9
    s_lshl_b32 s55, s55, 10
    s_mov_b32 m0, s55
    s_add_u32 s55, s55, s61
    buffer_load_dwordx4 v2, s[8:11], s55 offen lds
    s_add_u32 s55, s54, 12
    s_lshl_b32 s55, s55, 10
    s_mov_b32 m0, s55
    s_add_u32 s55, s55, s61
    buffer_load_dwordx4 v2, s[8:11], s55 offen lds
    s_add_u32 s55, s54, 15
    s_lshl_b32 s55, s55, 10
    s_mov_b32 m0, s55
    s_add_u32 s55, s55, s61
    buffer_load_dwordx4 v2, s[8:11], s55 offen lds
    s_add_u32 s55, s54, 18
    s_lshl_b32 s55, s55, 10
    s_mov_b32 m0, s55
    s_add_u32 s55, s55, s61
    buffer_load_dwordx4 v2, s[8:11], s55 offen lds
    s_add_u32 s55, s54, 21
    s_lshl_b32 s55, s55, 10
    s_mov_b32 m0, s55
    s_add_u32 s55, s55, s61
    buffer_load_dwordx4 v2, s[8:11], s55 offen lds
    s_add_u32 s55, s54, 24
    s_lshl_b32 s55, s55, 10
    s_mov_b32 m0, s55
    s_add_u32 s55, s55, s61
    buffer_load_dwordx4 v2, s[8:11], s55 offen lds
    s_add_u32 s55, s54, 27
    s_lshl_b32 s55, s55, 10
    s_mov_b32 m0, s55
    s_add_u32 s55, s55, s61
    buffer_load_dwordx4 v2, s[8:11], s55 offen lds
    s_add_u32 s55, s54, 30
    s_lshl_b32 s55, s55, 10
    s_mov_b32 m0, s55
    s_add_u32 s55, s55, s61
    buffer_load_dwordx4 v2, s[8:11], s55 offen lds
    s_add_u32 s55, s54, 33
    s_lshl_b32 s55, s55, 10
    s_mov_b32 m0, s55
    s_add_u32 s55, s55, s61
    buffer_load_dwordx4 v2, s[8:11], s55 offen lds
    s_add_u32 s55, s54, 36
    s_lshl_b32 s55, s55, 10
    s_mov_b32 m0, s55
    s_add_u32 s55, s55, s61
    buffer_load_dwordx4 v2, s[8:11], s55 offen lds
    s_add_u32 s55, s54, 39
    s_cmp_lt_u32 s55, 40
    s_cbranch_scc0 Lw13_10028
    s_add_u32 s55, s54, 39
    s_lshl_b32 s55, s55, 10
    s_mov_b32 m0, s55
    s_add_u32 s55, s55, s61
    buffer_load_dwordx4 v2, s[8:11], s55 offen lds
Lw13_10028:
    s_branch Lsh_g
Lsh_poller:
    s_mul_i32 s56, s14, 4352
    s_add_u32 s56, s56, 24903680
    v_and_b32 v4, 31, v1
    v_lshlrev_b32 v4, 2, v4
    s_mov_b32 s60, 0x40000
Lsh_poll:
    buffer_load_dword v7, v4, s[8:11], s56 offen sc1
    s_waitcnt vmcnt(0)
    v_cmp_eq_u32 vcc, s62, v7
    s_cmp_eq_u64 vcc, exec
    s_cbranch_scc1 Lsh_g
    s_sleep 4
    s_sub_u32 s60, s60, 1
    s_cbranch_scc0 Lsh_poll
Lsh_g:
    v_and_b32 v49, 15, v1
    s_lshl_b32 s45, s46, 4
    v_add_u32 v49, s45, v49
    v_lshlrev_b32 v50, 2, v49
    s_mov_b32 s58, 20971520
    buffer_load_dword v6, v50, s[8:11], s58 offen
    v_lshrrev_b32 v48, 4, v1
    v_mul_u32_u24 v7, 1280, v49
    v_lshl_add_u32 v5, v48, 3, v7
    s_waitcnt vmcnt(1) lgkmcnt(0)
    s_barrier
    s_add_u32 s55, s52, 0
    buffer_load_dwordx4 v[88:91], v2, s[8:11], s55 offen sc1
    s_add_u32 s55, s52, 1024
    buffer_load_dwordx4 v[92:95], v2, s[8:11], s55 offen sc1
    s_add_u32 s55, s52, 2048
    buffer_load_dwordx4 v[96:99], v2, s[8:11], s55 offen sc1
    s_add_u32 s55, s52, 3072
    buffer_load_dwordx4 v[100:103], v2, s[8:11], s55 offen sc1
    s_add_u32 s55, s52, 4096
    buffer_load_dwordx4 v[104:107], v2, s[8:11], s55 offen sc1
    s_add_u32 s55, s52, 5120
    buffer_load_dwordx4 v[108:111], v2, s[8:11], s55 offen sc1
    s_add_u32 s55, s52, 6144
    buffer_load_dwordx4 v[112:115], v2, s[8:11], s55 offen sc1
    s_add_u32 s55, s52, 7168
    buffer_load_dwordx4 v[116:119], v2, s[8:11], s55 offen sc1
    ds_read_b128 v[48:51], v3 offset:0
    ds_read_b128 v[52:55], v3 offset:1024
    ds_read_b128 v[56:59], v3 offset:2048
    ds_read_b128 v[60:63], v3 offset:3072
    ds_read_b128 v[64:67], v3 offset:4096
    s_add_u32 s55, s52, 8192
    buffer_load_dwordx4 v[120:123], v2, s[8:11], s55 offen sc1
    ds_read_b128 v[68:71], v3 offset:5120
    ds_read_b128 v[72:75], v3 offset:6144
    ds_read_b128 v[76:79], v3 offset:7168
    ds_read_b128 v[80:83], v3 offset:8192
    ds_read_b128 v[84:87], v3 offset:9216
    s_waitcnt vmcnt(8) lgkmcnt(5)
    v_mfma_f32_16x16x32_bf16 v[28:31], v[48:51], v[88:91], v[28:31]
    v_mfma_f32_16x16x32_bf16 v[32:35], v[52:55], v[88:91], v[32:35]
    v_mfma_f32_16x16x32_bf16 v[36:39], v[56:59], v[88:91], v[36:39]
    v_mfma_f32_16x16x32_bf16 v[40:43], v[60:63], v[88:91], v[40:43]
    v_mfma_f32_16x16x32_bf16 v[44:47], v[64:67], v[88:91], v[44:47]
    s_add_u32 s55, s52, 9216
    buffer_load_dwordx4 v[124:127], v2, s[8:11], s55 offen sc1
    ds_read_b128 v[48:51], v3 offset:10240
    ds_read_b128 v[52:55], v3 offset:11264
    ds_read_b128 v[56:59], v3 offset:12288
    ds_read_b128 v[60:63], v3 offset:13312
    ds_read_b128 v[64:67], v3 offset:14336
    s_waitcnt vmcnt(8) lgkmcnt(5)
    v_mfma_f32_16x16x32_bf16 v[28:31], v[68:71], v[92:95], v[28:31]
    v_mfma_f32_16x16x32_bf16 v[32:35], v[72:75], v[92:95], v[32:35]
    v_mfma_f32_16x16x32_bf16 v[36:39], v[76:79], v[92:95], v[36:39]
    v_mfma_f32_16x16x32_bf16 v[40:43], v[80:83], v[92:95], v[40:43]
    v_mfma_f32_16x16x32_bf16 v[44:47], v[84:87], v[92:95], v[44:47]
    s_add_u32 s55, s52, 10240
    buffer_load_dwordx4 v[128:131], v2, s[8:11], s55 offen sc1
    ds_read_b128 v[68:71], v3 offset:15360
    ds_read_b128 v[72:75], v3 offset:16384
    ds_read_b128 v[76:79], v3 offset:17408
    ds_read_b128 v[80:83], v3 offset:18432
    ds_read_b128 v[84:87], v3 offset:19456
    s_waitcnt vmcnt(8) lgkmcnt(5)
    v_mfma_f32_16x16x32_bf16 v[28:31], v[48:51], v[96:99], v[28:31]
    v_mfma_f32_16x16x32_bf16 v[32:35], v[52:55], v[96:99], v[32:35]
    v_mfma_f32_16x16x32_bf16 v[36:39], v[56:59], v[96:99], v[36:39]
    v_mfma_f32_16x16x32_bf16 v[40:43], v[60:63], v[96:99], v[40:43]
    v_mfma_f32_16x16x32_bf16 v[44:47], v[64:67], v[96:99], v[44:47]
    s_add_u32 s55, s52, 11264
    buffer_load_dwordx4 v[132:135], v2, s[8:11], s55 offen sc1
    ds_read_b128 v[48:51], v3 offset:20480
    ds_read_b128 v[52:55], v3 offset:21504
    ds_read_b128 v[56:59], v3 offset:22528
    ds_read_b128 v[60:63], v3 offset:23552
    ds_read_b128 v[64:67], v3 offset:24576
    s_waitcnt vmcnt(8) lgkmcnt(5)
    v_mfma_f32_16x16x32_bf16 v[28:31], v[68:71], v[100:103], v[28:31]
    v_mfma_f32_16x16x32_bf16 v[32:35], v[72:75], v[100:103], v[32:35]
    v_mfma_f32_16x16x32_bf16 v[36:39], v[76:79], v[100:103], v[36:39]
    v_mfma_f32_16x16x32_bf16 v[40:43], v[80:83], v[100:103], v[40:43]
    v_mfma_f32_16x16x32_bf16 v[44:47], v[84:87], v[100:103], v[44:47]
    s_add_u32 s55, s52, 12288
    buffer_load_dwordx4 v[136:139], v2, s[8:11], s55 offen sc1
    ds_read_b128 v[68:71], v3 offset:25600
    ds_read_b128 v[72:75], v3 offset:26624
    ds_read_b128 v[76:79], v3 offset:27648
    ds_read_b128 v[80:83], v3 offset:28672
    ds_read_b128 v[84:87], v3 offset:29696
    s_waitcnt vmcnt(8) lgkmcnt(5)
    v_mfma_f32_16x16x32_bf16 v[28:31], v[48:51], v[104:107], v[28:31]
    v_mfma_f32_16x16x32_bf16 v[32:35], v[52:55], v[104:107], v[32:35]
    v_mfma_f32_16x16x32_bf16 v[36:39], v[56:59], v[104:107], v[36:39]
    v_mfma_f32_16x16x32_bf16 v[40:43], v[60:63], v[104:107], v[40:43]
    v_mfma_f32_16x16x32_bf16 v[44:47], v[64:67], v[104:107], v[44:47]
    s_add_u32 s55, s52, 13312
    buffer_load_dwordx4 v[140:143], v2, s[8:11], s55 offen sc1
    ds_read_b128 v[48:51], v3 offset:30720
    ds_read_b128 v[52:55], v3 offset:31744
    ds_read_b128 v[56:59], v3 offset:32768
    ds_read_b128 v[60:63], v3 offset:33792
    ds_read_b128 v[64:67], v3 offset:34816
    s_waitcnt vmcnt(8) lgkmcnt(5)
    v_mfma_f32_16x16x32_bf16 v[28:31], v[68:71], v[108:111], v[28:31]
    v_mfma_f32_16x16x32_bf16 v[32:35], v[72:75], v[108:111], v[32:35]
    v_mfma_f32_16x16x32_bf16 v[36:39], v[76:79], v[108:111], v[36:39]
    v_mfma_f32_16x16x32_bf16 v[40:43], v[80:83], v[108:111], v[40:43]
    v_mfma_f32_16x16x32_bf16 v[44:47], v[84:87], v[108:111], v[44:47]
    s_add_u32 s55, s52, 14336
    buffer_load_dwordx4 v[144:147], v2, s[8:11], s55 offen sc1
    ds_read_b128 v[68:71], v3 offset:35840
    ds_read_b128 v[72:75], v3 offset:36864
    ds_read_b128 v[76:79], v3 offset:37888
    ds_read_b128 v[80:83], v3 offset:38912
    ds_read_b128 v[84:87], v3 offset:39936
    s_waitcnt vmcnt(8) lgkmcnt(5)
    v_mfma_f32_16x16x32_bf16 v[28:31], v[48:51], v[112:115], v[28:31]
    v_mfma_f32_16x16x32_bf16 v[32:35], v[52:55], v[112:115], v[32:35]
    v_mfma_f32_16x16x32_bf16 v[36:39], v[56:59], v[112:115], v[36:39]
    v_mfma_f32_16x16x32_bf16 v[40:43], v[60:63], v[112:115], v[40:43]
    v_mfma_f32_16x16x32_bf16 v[44:47], v[64:67], v[112:115], v[44:47]
    s_add_u32 s55, s52, 15360
    buffer_load_dwordx4 v[148:151], v2, s[8:11], s55 offen sc1
    ds_read_b128 v[48:51], v3 offset:40960
    ds_read_b128 v[52:55], v3 offset:41984
    ds_read_b128 v[56:59], v3 offset:43008
    ds_read_b128 v[60:63], v3 offset:44032
    ds_read_b128 v[64:67], v3 offset:45056
    s_waitcnt vmcnt(8) lgkmcnt(5)
    v_mfma_f32_16x16x32_bf16 v[28:31], v[68:71], v[116:119], v[28:31]
    v_mfma_f32_16x16x32_bf16 v[32:35], v[72:75], v[116:119], v[32:35]
    v_mfma_f32_16x16x32_bf16 v[36:39], v[76:79], v[116:119], v[36:39]
    v_mfma_f32_16x16x32_bf16 v[40:43], v[80:83], v[116:119], v[40:43]
    v_mfma_f32_16x16x32_bf16 v[44:47], v[84:87], v[116:119], v[44:47]
    s_add_u32 s55, s52, 16384
    buffer_load_dwordx4 v[152:155], v2, s[8:11], s55 offen sc1
    ds_read_b128 v[68:71], v3 offset:46080
    ds_read_b128 v[72:75], v3 offset:47104
    ds_read_b128 v[76:79], v3 offset:48128
    ds_read_b128 v[80:83], v3 offset:49152
    ds_read_b128 v[84:87], v3 offset:50176
    s_waitcnt vmcnt(8) lgkmcnt(5)
    v_mfma_f32_16x16x32_bf16 v[28:31], v[48:51], v[120:123], v[28:31]
    v_mfma_f32_16x16x32_bf16 v[32:35], v[52:55], v[120:123], v[32:35]
    v_mfma_f32_16x16x32_bf16 v[36:39], v[56:59], v[120:123], v[36:39]
    v_mfma_f32_16x16x32_bf16 v[40:43], v[60:63], v[120:123], v[40:43]
    v_mfma_f32_16x16x32_bf16 v[44:47], v[64:67], v[120:123], v[44:47]
    s_add_u32 s55, s52, 17408
    buffer_load_dwordx4 v[156:159], v2, s[8:11], s55 offen sc1
    ds_read_b128 v[48:51], v3 offset:51200
    ds_read_b128 v[52:55], v3 offset:52224
    ds_read_b128 v[56:59], v3 offset:53248
    ds_read_b128 v[60:63], v3 offset:54272
    ds_read_b128 v[64:67], v3 offset:55296
    s_waitcnt vmcnt(8) lgkmcnt(5)
    v_mfma_f32_16x16x32_bf16 v[28:31], v[68:71], v[124:127], v[28:31]
    v_mfma_f32_16x16x32_bf16 v[32:35], v[72:75], v[124:127], v[32:35]
    v_mfma_f32_16x16x32_bf16 v[36:39], v[76:79], v[124:127], v[36:39]
    v_mfma_f32_16x16x32_bf16 v[40:43], v[80:83], v[124:127], v[40:43]
    v_mfma_f32_16x16x32_bf16 v[44:47], v[84:87], v[124:127], v[44:47]
    s_add_u32 s55, s52, 18432
    buffer_load_dwordx4 v[160:163], v2, s[8:11], s55 offen sc1
    ds_read_b128 v[68:71], v3 offset:56320
    ds_read_b128 v[72:75], v3 offset:57344
    ds_read_b128 v[76:79], v3 offset:58368
    ds_read_b128 v[80:83], v3 offset:59392
    ds_read_b128 v[84:87], v3 offset:60416
    s_waitcnt vmcnt(8) lgkmcnt(5)
    v_mfma_f32_16x16x32_bf16 v[28:31], v[48:51], v[128:131], v[28:31]
    v_mfma_f32_16x16x32_bf16 v[32:35], v[52:55], v[128:131], v[32:35]
    v_mfma_f32_16x16x32_bf16 v[36:39], v[56:59], v[128:131], v[36:39]
    v_mfma_f32_16x16x32_bf16 v[40:43], v[60:63], v[128:131], v[40:43]
    v_mfma_f32_16x16x32_bf16 v[44:47], v[64:67], v[128:131], v[44:47]
    s_add_u32 s55, s52, 19456
    buffer_load_dwordx4 v[164:167], v2, s[8:11], s55 offen sc1
    ds_read_b128 v[48:51], v2 offset:0
    ds_read_b128 v[52:55], v2 offset:1024
    ds_read_b128 v[56:59], v2 offset:2048
    ds_read_b128 v[60:63], v2 offset:3072
    ds_read_b128 v[64:67], v2 offset:4096
    s_waitcnt vmcnt(8) lgkmcnt(5)
    v_mfma_f32_16x16x32_bf16 v[28:31], v[68:71], v[132:135], v[28:31]
    v_mfma_f32_16x16x32_bf16 v[32:35], v[72:75], v[132:135], v[32:35]
    v_mfma_f32_16x16x32_bf16 v[36:39], v[76:79], v[132:135], v[36:39]
    v_mfma_f32_16x16x32_bf16 v[40:43], v[80:83], v[132:135], v[40:43]
    v_mfma_f32_16x16x32_bf16 v[44:47], v[84:87], v[132:135], v[44:47]
    ds_read_b128 v[68:71], v2 offset:5120
    ds_read_b128 v[72:75], v2 offset:6144
    ds_read_b128 v[76:79], v2 offset:7168
    ds_read_b128 v[80:83], v2 offset:8192
    ds_read_b128 v[84:87], v2 offset:9216
    s_waitcnt vmcnt(7) lgkmcnt(5)
    v_mfma_f32_16x16x32_bf16 v[28:31], v[48:51], v[136:139], v[28:31]
    v_mfma_f32_16x16x32_bf16 v[32:35], v[52:55], v[136:139], v[32:35]
    v_mfma_f32_16x16x32_bf16 v[36:39], v[56:59], v[136:139], v[36:39]
    v_mfma_f32_16x16x32_bf16 v[40:43], v[60:63], v[136:139], v[40:43]
    v_mfma_f32_16x16x32_bf16 v[44:47], v[64:67], v[136:139], v[44:47]
    ds_read_b128 v[48:51], v2 offset:10240
    ds_read_b128 v[52:55], v2 offset:11264
    ds_read_b128 v[56:59], v2 offset:12288
    ds_read_b128 v[60:63], v2 offset:13312
    ds_read_b128 v[64:67], v2 offset:14336
    s_waitcnt vmcnt(6) lgkmcnt(5)
    v_mfma_f32_16x16x32_bf16 v[28:31], v[68:71], v[140:143], v[28:31]
    v_mfma_f32_16x16x32_bf16 v[32:35], v[72:75], v[140:143], v[32:35]
    v_mfma_f32_16x16x32_bf16 v[36:39], v[76:79], v[140:143], v[36:39]
    v_mfma_f32_16x16x32_bf16 v[40:43], v[80:83], v[140:143], v[40:43]
    v_mfma_f32_16x16x32_bf16 v[44:47], v[84:87], v[140:143], v[44:47]
    ds_read_b128 v[68:71], v2 offset:15360
    ds_read_b128 v[72:75], v2 offset:16384
    ds_read_b128 v[76:79], v2 offset:17408
    ds_read_b128 v[80:83], v2 offset:18432
    ds_read_b128 v[84:87], v2 offset:19456
    s_waitcnt vmcnt(5) lgkmcnt(5)
    v_mfma_f32_16x16x32_bf16 v[28:31], v[48:51], v[144:147], v[28:31]
    v_mfma_f32_16x16x32_bf16 v[32:35], v[52:55], v[144:147], v[32:35]
    v_mfma_f32_16x16x32_bf16 v[36:39], v[56:59], v[144:147], v[36:39]
    v_mfma_f32_16x16x32_bf16 v[40:43], v[60:63], v[144:147], v[40:43]
    v_mfma_f32_16x16x32_bf16 v[44:47], v[64:67], v[144:147], v[44:47]
    ds_read_b128 v[48:51], v2 offset:20480
    ds_read_b128 v[52:55], v2 offset:21504
    ds_read_b128 v[56:59], v2 offset:22528
    ds_read_b128 v[60:63], v2 offset:23552
    ds_read_b128 v[64:67], v2 offset:24576
    s_waitcnt vmcnt(4) lgkmcnt(5)
    v_mfma_f32_16x16x32_bf16 v[28:31], v[68:71], v[148:151], v[28:31]
    v_mfma_f32_16x16x32_bf16 v[32:35], v[72:75], v[148:151], v[32:35]
    v_mfma_f32_16x16x32_bf16 v[36:39], v[76:79], v[148:151], v[36:39]
    v_mfma_f32_16x16x32_bf16 v[40:43], v[80:83], v[148:151], v[40:43]
    v_mfma_f32_16x16x32_bf16 v[44:47], v[84:87], v[148:151], v[44:47]
    ds_read_b128 v[68:71], v2 offset:25600
    ds_read_b128 v[72:75], v2 offset:26624
    ds_read_b128 v[76:79], v2 offset:27648
    ds_read_b128 v[80:83], v2 offset:28672
    ds_read_b128 v[84:87], v2 offset:29696
    s_waitcnt vmcnt(3) lgkmcnt(5)
    v_mfma_f32_16x16x32_bf16 v[28:31], v[48:51], v[152:155], v[28:31]
    v_mfma_f32_16x16x32_bf16 v[32:35], v[52:55], v[152:155], v[32:35]
    v_mfma_f32_16x16x32_bf16 v[36:39], v[56:59], v[152:155], v[36:39]
    v_mfma_f32_16x16x32_bf16 v[40:43], v[60:63], v[152:155], v[40:43]
    v_mfma_f32_16x16x32_bf16 v[44:47], v[64:67], v[152:155], v[44:47]
    ds_read_b128 v[48:51], v2 offset:30720
    ds_read_b128 v[52:55], v2 offset:31744
    ds_read_b128 v[56:59], v2 offset:32768
    ds_read_b128 v[60:63], v2 offset:33792
    ds_read_b128 v[64:67], v2 offset:34816
    s_waitcnt vmcnt(2) lgkmcnt(5)
    v_mfma_f32_16x16x32_bf16 v[28:31], v[68:71], v[156:159], v[28:31]
    v_mfma_f32_16x16x32_bf16 v[32:35], v[72:75], v[156:159], v[32:35]
    v_mfma_f32_16x16x32_bf16 v[36:39], v[76:79], v[156:159], v[36:39]
    v_mfma_f32_16x16x32_bf16 v[40:43], v[80:83], v[156:159], v[40:43]
    v_mfma_f32_16x16x32_bf16 v[44:47], v[84:87], v[156:159], v[44:47]
    ds_read_b128 v[68:71], v2 offset:35840
    ds_read_b128 v[72:75], v2 offset:36864
    ds_read_b128 v[76:79], v2 offset:37888
    ds_read_b128 v[80:83], v2 offset:38912
    ds_read_b128 v[84:87], v2 offset:39936
    s_waitcnt vmcnt(1) lgkmcnt(5)
    v_mfma_f32_16x16x32_bf16 v[28:31], v[48:51], v[160:163], v[28:31]
    v_mfma_f32_16x16x32_bf16 v[32:35], v[52:55], v[160:163], v[32:35]
    v_mfma_f32_16x16x32_bf16 v[36:39], v[56:59], v[160:163], v[36:39]
    v_mfma_f32_16x16x32_bf16 v[40:43], v[60:63], v[160:163], v[40:43]
    v_mfma_f32_16x16x32_bf16 v[44:47], v[64:67], v[160:163], v[44:47]
    s_waitcnt vmcnt(0) lgkmcnt(0)
    v_mfma_f32_16x16x32_bf16 v[28:31], v[68:71], v[164:167], v[28:31]
    v_mfma_f32_16x16x32_bf16 v[32:35], v[72:75], v[164:167], v[32:35]
    v_mfma_f32_16x16x32_bf16 v[36:39], v[76:79], v[164:167], v[36:39]
    v_mfma_f32_16x16x32_bf16 v[40:43], v[80:83], v[164:167], v[40:43]
    v_mfma_f32_16x16x32_bf16 v[44:47], v[84:87], v[164:167], v[44:47]
    s_nop 7
    s_mul_i32 s48, s43, 160
    v_sub_f32 v28, v28, v8
    v_sub_f32 v29, v29, v9
    v_sub_f32 v30, v30, v10
    v_sub_f32 v31, v31, v11
    v_fma_f32 v28, v6, v28, v8
    v_fma_f32 v29, v6, v29, v9
    v_fma_f32 v30, v6, v30, v10
    v_fma_f32 v31, v6, v31, v11
    v_cvt_pk_bf16_f32 v48, v28, v29
    v_cvt_pk_bf16_f32 v49, v30, v31
    buffer_store_dwordx2 v[48:49], v5, s[24:27], s48 offen offset:0
    v_sub_f32 v32, v32, v12
    v_sub_f32 v33, v33, v13
    v_sub_f32 v34, v34, v14
    v_sub_f32 v35, v35, v15
    v_fma_f32 v32, v6, v32, v12
    v_fma_f32 v33, v6, v33, v13
    v_fma_f32 v34, v6, v34, v14
    v_fma_f32 v35, v6, v35, v15
    v_cvt_pk_bf16_f32 v50, v32, v33
    v_cvt_pk_bf16_f32 v51, v34, v35
    buffer_store_dwordx2 v[50:51], v5, s[24:27], s48 offen offset:32
    v_sub_f32 v36, v36, v16
    v_sub_f32 v37, v37, v17
    v_sub_f32 v38, v38, v18
    v_sub_f32 v39, v39, v19
    v_fma_f32 v36, v6, v36, v16
    v_fma_f32 v37, v6, v37, v17
    v_fma_f32 v38, v6, v38, v18
    v_fma_f32 v39, v6, v39, v19
    v_cvt_pk_bf16_f32 v52, v36, v37
    v_cvt_pk_bf16_f32 v53, v38, v39
    buffer_store_dwordx2 v[52:53], v5, s[24:27], s48 offen offset:64
    v_sub_f32 v40, v40, v20
    v_sub_f32 v41, v41, v21
    v_sub_f32 v42, v42, v22
    v_sub_f32 v43, v43, v23
    v_fma_f32 v40, v6, v40, v20
    v_fma_f32 v41, v6, v41, v21
    v_fma_f32 v42, v6, v42, v22
    v_fma_f32 v43, v6, v43, v23
    v_cvt_pk_bf16_f32 v54, v40, v41
    v_cvt_pk_bf16_f32 v55, v42, v43
    buffer_store_dwordx2 v[54:55], v5, s[24:27], s48 offen offset:96
    v_sub_f32 v44, v44, v24
    v_sub_f32 v45, v45, v25
    v_sub_f32 v46, v46, v26
    v_sub_f32 v47, v47, v27
    v_fma_f32 v44, v6, v44, v24
    v_fma_f32 v45, v6, v45, v25
    v_fma_f32 v46, v6, v46, v26
    v_fma_f32 v47, v6, v47, v27
    v_cvt_pk_bf16_f32 v56, v44, v45
    v_cvt_pk_bf16_f32 v57, v46, v47
    buffer_store_dwordx2 v[56:57], v5, s[24:27], s48 offen offset:128
    s_endpgm
Lcode_end:
    s_endpgm
.section .rodata,"a"
.p2align 6
.amdhsa_kernel gated_mix__softmax_full_mha__dense_activation_mish__prompt_kernel
  .amdhsa_next_free_vgpr 168
  .amdhsa_next_free_sgpr 102
  .amdhsa_accum_offset 168
  .amdhsa_group_segment_fixed_size 0
  .amdhsa_kernarg_size 88
  .amdhsa_user_sgpr_count 2
  .amdhsa_user_sgpr_kernarg_segment_ptr 1
  .amdhsa_system_sgpr_workgroup_id_x 1
.end_amdhsa_kernel
```
